```python
import torch

def _softmax(x, axis=-1):
    return torch.softmax(x, dim=axis)
def _gelu(x):
    return torch.nn.functional.gelu(x, approximate="tanh")
def _silu(x):
    return torch.nn.functional.silu(x)
def _sigmoid(x):
    return torch.sigmoid(x)
def _layernorm(x, axis=-1, eps=1e-5):
    m = x.mean(dim=axis, keepdim=True)
    v = x.var(dim=axis, keepdim=True, unbiased=False)
    return (x - m) / torch.sqrt(v + eps)
def _scatter_add(tgt, idx, src, axis=0):
    return tgt.clone().index_add_(axis, idx, src)
def _segment_sum(src, seg, n):
    out = torch.zeros((n,) + src.shape[1:], dtype=src.dtype)
    return out.index_add_(0, seg, src)
def _pad(x, pw):
    flat = tuple(v for pair in reversed(pw) for v in pair)
    return torch.nn.functional.pad(x, flat)

kernel_name = 'sequential_preLN__gqa_block_cached__geglu_ffn__decode'

def setup_inputs():

    _w = (lambda a: (lambda t: t.to(torch.bfloat16) if t.is_floating_point() else t)(torch.as_tensor(a)))
    def _A_setup():
        B, Sq, D = 2, 1, 576
        Hq, Hkv, Sk, Dh = 32, 16, 8192, 128
        assert Hq % Hkv == 0, (Hq, Hkv)
        return {
            "x": _w((lambda *s: torch.randn(*s, dtype=torch.bfloat16) * 0.05)(B, Sq, D)),
            "k_cache": _w((lambda *s: torch.randn(*s, dtype=torch.bfloat16) * 3.2)(B, Hkv, Sk, Dh)),
            "v_cache": _w((lambda *s: torch.randn(*s, dtype=torch.bfloat16) * 0.4)(B, Hkv, Sk, Dh)),
            "wq": _w((lambda *s: torch.randn(*s, dtype=torch.bfloat16) * 3.2)(D, Hq * Dh) * (D ** -0.5)),
            "wo": _w((lambda *s: torch.randn(*s, dtype=torch.bfloat16) * 0.4)(Hq * Dh, D) * ((Hq * Dh) ** -0.5)),
        }
    _A_in = _A_setup()

    def _B_setup():
        B, S, D, F = 2, 1, 576, 4608
        return {
            "x": _w((lambda *s: torch.randn(*s, dtype=torch.bfloat16) * 0.05)(B, S, D)),
            "w_gate": _w((lambda *s: torch.randn(*s, dtype=torch.bfloat16) * 0.05)(D, F)),
            "w_up": _w((lambda *s: torch.randn(*s, dtype=torch.bfloat16) * 0.05)(D, F)),
            "w_down": _w((lambda *s: torch.randn(*s, dtype=torch.bfloat16) * 0.05)(F, D)),
        }
    _B_in = _B_setup()

    return {
        "A_x": _A_in["x"],
        "A_k_cache": _A_in["k_cache"],
        "A_v_cache": _A_in["v_cache"],
        "A_wq": _A_in["wq"],
        "A_wo": _A_in["wo"],
        "B_x": _B_in["x"],
        "B_w_gate": _B_in["w_gate"],
        "B_w_up": _B_in["w_up"],
        "B_w_down": _B_in["w_down"],
    }

def reference(A_x, A_k_cache, A_v_cache, A_wq, A_wo, B_x, B_w_gate, B_w_up, B_w_down):
    def _A_ref(x, k_cache, v_cache, wq, wo):
        B, Sq, D = x.shape
        Hq, Dh = 32, 128
        Hkv = k_cache.shape[1]
        rep = Hq // Hkv
        q = (lambda x, *d: x.permute(*d))((x @ wq).reshape(B, Sq, Hq, Dh), 0, 2, 1, 3)
        k = (lambda x, n, axis: torch.repeat_interleave(x, n, dim=axis))(k_cache, rep, axis=1)
        v = (lambda x, n, axis: torch.repeat_interleave(x, n, dim=axis))(v_cache, rep, axis=1)
        scores = torch.einsum("bhqd,bhkd->bhqk", q, k) * (Dh ** -0.5)
        p = _softmax(scores, axis=-1)
        o = torch.einsum("bhqk,bhkd->bhqd", p, v)
        return (lambda x, *d: x.permute(*d))(o, 0, 2, 1, 3).reshape(B, Sq, Hq * Dh) @ wo

    def _B_ref(x, w_gate, w_up, w_down):
        return (_gelu(x @ w_gate) * (x @ w_up)) @ w_down

    x = A_x
    h = x + _A_ref(_layernorm(x, axis=-1), A_k_cache, A_v_cache, A_wq, A_wo)
    h2 = h + _B_ref(_layernorm(h, axis=-1), B_w_gate, B_w_up, B_w_down)
    return h2
```

```asm
; @launch grid=(256,1,1) block=(512,1,1) lds=100352
.amdgcn_target "amdgcn-amd-amdhsa--gfx950"
.text
.globl sequential_preLN__gqa_block_cached__geglu_ffn__decode_kernel
.p2align 8
.type sequential_preLN__gqa_block_cached__geglu_ffn__decode_kernel,@function
sequential_preLN__gqa_block_cached__geglu_ffn__decode_kernel:
    s_load_dwordx16 s[4:19], s[0:1], 0
    s_load_dwordx8 s[20:27], s[0:1], 64
    s_cmp_ge_u32 s2, 256
    s_cbranch_scc1 L_end
    v_lshrrev_b32 v1, 6, v0
    v_and_b32 v0, 63, v0
    v_readfirstlane_b32 s3, v1
    v_mov_b32 v4, 0
    v_mov_b32 v5, 0
    v_mov_b32 v6, 0
    v_mov_b32 v7, 0
    ds_write_b128 v4, v[4:7] offset:3008
    ds_write_b128 v4, v[4:7] offset:3024
    s_cmp_lt_u32 s3, 4
    s_cbranch_scc1 L_service
L_stream:
    s_sub_u32 s44, s3, 4
    v_lshlrev_b32 v1, 4, v0
    s_lshr_b32 s56, s2, 3
    s_lshl_b32 s46, s56, 21
    s_add_u32 s45, s2, s56
    s_and_b32 s45, s45, 7
    s_mul_i32 s45, s45, 4
    s_add_u32 s45, s45, s44
    s_lshl_b32 s45, s45, 12
    s_waitcnt lgkmcnt(0)
    s_add_u32 s36, s6, s46
    s_addc_u32 s37, s7, 0
    s_mov_b32 s38, 0x200000
    s_mov_b32 s39, 0x20000
    s_add_u32 s40, s8, s46
    s_addc_u32 s41, s9, 0
    s_mov_b32 s42, 0x200000
    s_mov_b32 s43, 0x20000
    buffer_load_dwordx4 v[84:87], v1, s[36:39], s45 offen offset:0 nt
    buffer_load_dwordx4 v[88:91], v1, s[36:39], s45 offen offset:1024 nt
    buffer_load_dwordx4 v[92:95], v1, s[36:39], s45 offen offset:2048 nt
    buffer_load_dwordx4 v[96:99], v1, s[36:39], s45 offen offset:3072 nt
    buffer_load_dwordx4 v[100:103], v1, s[40:43], s45 offen offset:0 nt
    buffer_load_dwordx4 v[104:107], v1, s[40:43], s45 offen offset:1024 nt
    buffer_load_dwordx4 v[108:111], v1, s[40:43], s45 offen offset:2048 nt
    buffer_load_dwordx4 v[112:115], v1, s[40:43], s45 offen offset:3072 nt
    s_mov_b32 s28, s26
    s_mov_b32 s29, s27
    s_mov_b32 s30, 0x10000000
    s_mov_b32 s31, 0x20000
    v_and_b32 v26, 1, v0
    v_lshlrev_b32 v26, 4, v26
    v_mov_b32 v27, 0xffff
    v_lshlrev_b32 v27, v26, v27
    v_bfe_u32 v26, v0, 1, 2
    v_cmp_eq_u32 vcc, 0, v26
    s_nop 1
    v_cndmask_b32 v5, 0, v27, vcc
    v_cmp_eq_u32 vcc, 1, v26
    s_nop 1
    v_cndmask_b32 v6, 0, v27, vcc
    v_cmp_eq_u32 vcc, 2, v26
    s_nop 1
    v_cndmask_b32 v7, 0, v27, vcc
    v_cmp_eq_u32 vcc, 3, v26
    s_nop 1
    v_cndmask_b32 v8, 0, v27, vcc
    v_mov_b32 v29, 0xfe967699
    v_mov_b32 v30, 0xfed91297
    v_mov_b32 v31, 0
    v_mov_b32 v32, 0
    v_mov_b32 v33, 0
    v_mov_b32 v34, 0
    v_mov_b32 v35, 0
    s_mov_b32 s46, 0xffff0000
    s_mov_b32 s47, 0x3db504f3
    s_mov_b32 s48, 0x3fb8aa3b
    s_mov_b32 s52, 0
    s_mov_b32 s53, -1
    v_and_b32 v9, 15, v0
    v_lshlrev_b32 v9, 4, v9
    v_mov_b32 v2, 0
    v_mov_b32 v3, 1
    v_mov_b32 v4, 0
    s_lshl_b32 s56, s56, 8
    s_add_u32 s56, s56, 0x1000
    s_add_u32 s54, s26, s56
    s_addc_u32 s55, s27, 0
    s_lshr_b32 s59, s2, 3
    s_add_u32 s61, s2, s59
    s_and_b32 s61, s61, 7
    s_cmp_lt_u32 s61, 2
    s_cselect_b32 s61, 2, 5
    s_barrier
    s_add_u32 s45, s45, 0x20000
    s_waitcnt vmcnt(7)
    buffer_load_dwordx4 v[116:119], v1, s[36:39], s45 offen offset:0 nt
    s_waitcnt vmcnt(7)
    buffer_load_dwordx4 v[120:123], v1, s[36:39], s45 offen offset:1024 nt
    s_waitcnt vmcnt(7)
    buffer_load_dwordx4 v[124:127], v1, s[36:39], s45 offen offset:2048 nt
    s_waitcnt vmcnt(7)
    buffer_load_dwordx4 v[128:131], v1, s[36:39], s45 offen offset:3072 nt
    s_waitcnt vmcnt(7)
    buffer_load_dwordx4 v[132:135], v1, s[40:43], s45 offen offset:0 nt
    s_waitcnt vmcnt(7)
    buffer_load_dwordx4 v[136:139], v1, s[40:43], s45 offen offset:1024 nt
    s_waitcnt vmcnt(7)
    buffer_load_dwordx4 v[140:143], v1, s[40:43], s45 offen offset:2048 nt
    s_waitcnt vmcnt(7)
    buffer_load_dwordx4 v[144:147], v1, s[40:43], s45 offen offset:3072 nt
    s_add_u32 s45, s45, 0x20000
    s_waitcnt vmcnt(7)
    buffer_load_dwordx4 v[148:151], v1, s[36:39], s45 offen offset:0 nt
    s_waitcnt vmcnt(7)
    buffer_load_dwordx4 v[152:155], v1, s[36:39], s45 offen offset:1024 nt
    s_waitcnt vmcnt(7)
    buffer_load_dwordx4 v[156:159], v1, s[36:39], s45 offen offset:2048 nt
    s_waitcnt vmcnt(7)
    buffer_load_dwordx4 v[160:163], v1, s[36:39], s45 offen offset:3072 nt
    s_waitcnt vmcnt(7)
    buffer_load_dwordx4 v[164:167], v1, s[40:43], s45 offen offset:0 nt
    s_waitcnt vmcnt(7)
    buffer_load_dwordx4 v[168:171], v1, s[40:43], s45 offen offset:1024 nt
    s_waitcnt vmcnt(7)
    buffer_load_dwordx4 v[172:175], v1, s[40:43], s45 offen offset:2048 nt
    s_waitcnt vmcnt(7)
    buffer_load_dwordx4 v[176:179], v1, s[40:43], s45 offen offset:3072 nt
    s_add_u32 s45, s45, 0x20000
    s_waitcnt vmcnt(7)
    buffer_load_dwordx4 v[180:183], v1, s[36:39], s45 offen offset:0 nt
    s_waitcnt vmcnt(7)
    buffer_load_dwordx4 v[184:187], v1, s[36:39], s45 offen offset:1024 nt
    s_waitcnt vmcnt(7)
    buffer_load_dwordx4 v[188:191], v1, s[36:39], s45 offen offset:2048 nt
    s_waitcnt vmcnt(7)
    buffer_load_dwordx4 v[192:195], v1, s[36:39], s45 offen offset:3072 nt
    s_waitcnt vmcnt(7)
    buffer_load_dwordx4 v[196:199], v1, s[40:43], s45 offen offset:0 nt
    s_waitcnt vmcnt(7)
    buffer_load_dwordx4 v[200:203], v1, s[40:43], s45 offen offset:1024 nt
    s_waitcnt vmcnt(7)
    buffer_load_dwordx4 v[204:207], v1, s[40:43], s45 offen offset:2048 nt
    s_waitcnt vmcnt(7)
    buffer_load_dwordx4 v[208:211], v1, s[40:43], s45 offen offset:3072 nt
    ds_write_b32 v2, v3 offset:3020
    s_add_u32 s45, s45, 0x20000
    s_waitcnt vmcnt(7)
    buffer_load_dwordx4 v[212:215], v1, s[36:39], s45 offen offset:0 nt
    s_waitcnt vmcnt(7)
    buffer_load_dwordx4 v[216:219], v1, s[36:39], s45 offen offset:1024 nt
    s_waitcnt vmcnt(7)
    buffer_load_dwordx4 v[220:223], v1, s[36:39], s45 offen offset:2048 nt
    s_waitcnt vmcnt(7)
    buffer_load_dwordx4 v[224:227], v1, s[36:39], s45 offen offset:3072 nt
    s_waitcnt vmcnt(7)
    buffer_load_dwordx4 v[228:231], v1, s[40:43], s45 offen offset:0 nt
    s_waitcnt vmcnt(7)
    buffer_load_dwordx4 v[232:235], v1, s[40:43], s45 offen offset:1024 nt
    s_waitcnt vmcnt(7)
    buffer_load_dwordx4 v[236:239], v1, s[40:43], s45 offen offset:2048 nt
    s_waitcnt vmcnt(7)
    buffer_load_dwordx4 v[240:243], v1, s[40:43], s45 offen offset:3072 nt
    s_add_u32 s45, s45, 0x20000
    s_waitcnt vmcnt(7)
    buffer_load_dwordx4 v[52:55], v1, s[36:39], s45 offen offset:0 nt
    s_waitcnt vmcnt(7)
    buffer_load_dwordx4 v[56:59], v1, s[36:39], s45 offen offset:1024 nt
    s_waitcnt vmcnt(7)
    buffer_load_dwordx4 v[60:63], v1, s[36:39], s45 offen offset:2048 nt
    s_waitcnt vmcnt(7)
    buffer_load_dwordx4 v[64:67], v1, s[36:39], s45 offen offset:3072 nt
    s_waitcnt vmcnt(7)
    buffer_load_dwordx4 v[68:71], v1, s[40:43], s45 offen offset:0 nt
    s_waitcnt vmcnt(7)
    buffer_load_dwordx4 v[72:75], v1, s[40:43], s45 offen offset:1024 nt
    s_waitcnt vmcnt(7)
    buffer_load_dwordx4 v[76:79], v1, s[40:43], s45 offen offset:2048 nt
    s_waitcnt vmcnt(7)
    buffer_load_dwordx4 v[80:83], v1, s[40:43], s45 offen offset:3072 nt
    v_mov_b32 v26, 0
    s_mov_b32 s60, 0
L_lw_1:
    ds_read_b32 v27, v26 offset:3028
    s_waitcnt lgkmcnt(0)
    v_cmp_le_u32 vcc, 1, v27
    s_add_u32 s60, s60, 1
    s_cmp_gt_u32 s60, 4000000
    s_cbranch_scc1 L_lw_1_x
    s_cbranch_vccnz L_lw_1_x
    s_sleep 1
    s_branch L_lw_1
L_lw_1_x:
    ds_read_b128 v[10:13], v9 offset:0
    ds_read_b128 v[14:17], v9 offset:256
    s_mov_b32 s49, 0
    s_waitcnt lgkmcnt(0)
    v_and_b32 v9, 8, v0
    s_lshl_b32 s57, s44, 4
    s_add_u32 s57, s57, 2944
    v_add_u32 v9, s57, v9
    s_lshl_b32 s57, s44, 10
    v_add_u32 v4, s57, v1
    s_mov_b32 s57, 0
    s_mov_b32 s96, 0
L_sloop:
    s_waitcnt vmcnt(7) lgkmcnt(0)
    s_add_u32 s45, s45, 0x20000
    s_and_b32 s58, s57, 7
    s_lshr_b32 s56, s57, 3
    s_lshl_b32 s56, s56, 5
    s_add_u32 s58, s58, s56
    s_add_u32 s58, s58, 256
    s_add_u32 s56, s57, 328
    s_cmp_lt_u32 s57, 24
    s_cselect_b32 s57, s58, s56
    s_lshl_b32 s57, s57, 12
    s_cmp_lt_u32 s49, s61
    s_cselect_b32 s45, s45, s57
    s_add_u32 s56, s49, 1
    s_cmp_ge_u32 s56, s61
    s_cselect_b32 s62, 1, 0
    s_cmp_lt_u32 s45, 0x200000
    s_cbranch_scc1 L_sgo
    s_mov_b32 s38, 0
    s_mov_b32 s42, 0
    s_mov_b32 s62, 0
    s_mov_b64 exec, 1
    ds_add_u32 v2, v3 offset:3012
    ds_write_b32 v2, v3 offset:3024
    s_mov_b64 exec, -1
L_sgo:
    s_cmp_lg_u32 s49, 3
    s_cbranch_scc1 L_sgo2
    ds_write_b32 v2, v3 offset:3024
L_sgo2:
    v_dot2_f32_bf16 v18, v52, v10, 0
    v_dot2_f32_bf16 v22, v52, v14, 0
    v_dot2_f32_bf16 v18, v53, v11, v18
    v_dot2_f32_bf16 v22, v53, v15, v22
    v_dot2_f32_bf16 v18, v54, v12, v18
    v_dot2_f32_bf16 v22, v54, v16, v22
    v_dot2_f32_bf16 v18, v55, v13, v18
    v_dot2_f32_bf16 v22, v55, v17, v22
    buffer_load_dwordx4 v[52:55], v1, s[36:39], s45 offen offset:0 nt
    s_waitcnt vmcnt(7)
    v_dot2_f32_bf16 v19, v56, v10, 0
    v_dot2_f32_bf16 v23, v56, v14, 0
    v_dot2_f32_bf16 v19, v57, v11, v19
    v_dot2_f32_bf16 v23, v57, v15, v23
    v_dot2_f32_bf16 v19, v58, v12, v19
    v_dot2_f32_bf16 v23, v58, v16, v23
    v_dot2_f32_bf16 v19, v59, v13, v19
    v_dot2_f32_bf16 v23, v59, v17, v23
    buffer_load_dwordx4 v[56:59], v1, s[36:39], s45 offen offset:1024 nt
    s_waitcnt vmcnt(7)
    v_dot2_f32_bf16 v20, v60, v10, 0
    v_dot2_f32_bf16 v24, v60, v14, 0
    v_dot2_f32_bf16 v20, v61, v11, v20
    v_dot2_f32_bf16 v24, v61, v15, v24
    v_dot2_f32_bf16 v20, v62, v12, v20
    v_dot2_f32_bf16 v24, v62, v16, v24
    v_dot2_f32_bf16 v20, v63, v13, v20
    v_dot2_f32_bf16 v24, v63, v17, v24
    buffer_load_dwordx4 v[60:63], v1, s[36:39], s45 offen offset:2048 nt
    s_waitcnt vmcnt(7)
    s_mov_b32 s57, 1
    s_cmp_eq_u32 s62, 0
    s_cbranch_scc1 L_nclaim
    s_atomic_add s57, s[54:55], 0x0 glc
L_nclaim:
    v_dot2_f32_bf16 v21, v64, v10, 0
    v_dot2_f32_bf16 v25, v64, v14, 0
    v_dot2_f32_bf16 v21, v65, v11, v21
    v_dot2_f32_bf16 v25, v65, v15, v25
    v_dot2_f32_bf16 v21, v66, v12, v21
    v_dot2_f32_bf16 v25, v66, v16, v25
    v_dot2_f32_bf16 v21, v67, v13, v21
    v_dot2_f32_bf16 v25, v67, v17, v25
    buffer_load_dwordx4 v[64:67], v1, s[36:39], s45 offen offset:3072 nt
    v_add_f32_dpp v18, v18, v18 row_ror:8 row_mask:0xf bank_mask:0x3
    v_add_f32_dpp v19, v19, v19 row_ror:8 row_mask:0xf bank_mask:0x3
    v_add_f32_dpp v20, v20, v20 row_ror:8 row_mask:0xf bank_mask:0x3
    v_add_f32_dpp v21, v21, v21 row_ror:8 row_mask:0xf bank_mask:0x3
    v_add_f32_dpp v18, v22, v22 row_ror:8 row_mask:0xf bank_mask:0xc
    v_add_f32_dpp v19, v23, v23 row_ror:8 row_mask:0xf bank_mask:0xc
    v_add_f32_dpp v20, v24, v24 row_ror:8 row_mask:0xf bank_mask:0xc
    v_add_f32_dpp v21, v25, v25 row_ror:8 row_mask:0xf bank_mask:0xc
    v_add_f32_dpp v18, v18, v18 row_half_mirror row_mask:0xf bank_mask:0xf
    v_add_f32_dpp v19, v19, v19 row_half_mirror row_mask:0xf bank_mask:0xf
    v_add_f32_dpp v20, v20, v20 row_half_mirror row_mask:0xf bank_mask:0xf
    v_add_f32_dpp v21, v21, v21 row_half_mirror row_mask:0xf bank_mask:0xf
    v_add_f32_dpp v18, v18, v18 quad_perm:[1,0,3,2] row_mask:0xf bank_mask:0xf
    v_add_f32_dpp v19, v19, v19 quad_perm:[1,0,3,2] row_mask:0xf bank_mask:0xf
    v_add_f32_dpp v20, v20, v20 quad_perm:[1,0,3,2] row_mask:0xf bank_mask:0xf
    v_add_f32_dpp v21, v21, v21 quad_perm:[1,0,3,2] row_mask:0xf bank_mask:0xf
    v_add_f32_dpp v18, v18, v18 quad_perm:[2,3,0,1] row_mask:0xf bank_mask:0xf
    v_add_f32_dpp v19, v19, v19 quad_perm:[2,3,0,1] row_mask:0xf bank_mask:0xf
    v_add_f32_dpp v20, v20, v20 quad_perm:[2,3,0,1] row_mask:0xf bank_mask:0xf
    v_add_f32_dpp v21, v21, v21 quad_perm:[2,3,0,1] row_mask:0xf bank_mask:0xf
    v_cvt_pk_bf16_f32 v26, v18, v19
    v_cvt_pk_bf16_f32 v27, v20, v21
    v_lshlrev_b32 v18, 16, v26
    v_and_b32 v19, s46, v26
    v_lshlrev_b32 v20, 16, v27
    v_and_b32 v21, s46, v27
    v_mul_f32 v18, s47, v18
    v_mul_f32 v19, s47, v19
    v_mul_f32 v20, s47, v20
    v_mul_f32 v21, s47, v21
    v_cvt_pk_bf16_f32 v26, v18, v19
    v_cvt_pk_bf16_f32 v27, v20, v21
    v_lshlrev_b32 v18, 16, v26
    v_and_b32 v19, s46, v26
    v_lshlrev_b32 v20, 16, v27
    v_and_b32 v21, s46, v27
    v_max3_f32 v28, v18, v19, v20
    v_max_f32 v28, v28, v21
    v_cmp_gt_f32 vcc, v28, v29
    s_cbranch_vccz L_nors_2
    s_call_b64 s[50:51], L_rescale
L_nors_2:
    v_fma_f32 v18, v18, s48, -v30
    v_fma_f32 v19, v19, s48, -v30
    v_fma_f32 v20, v20, s48, -v30
    v_fma_f32 v21, v21, s48, -v30
    v_exp_f32 v18, v18
    v_exp_f32 v19, v19
    v_exp_f32 v20, v20
    v_exp_f32 v21, v21
    s_nop 0
    v_cvt_pk_bf16_f32 v22, v18, v18
    v_cvt_pk_bf16_f32 v23, v19, v19
    v_cvt_pk_bf16_f32 v24, v20, v20
    v_cvt_pk_bf16_f32 v25, v21, v21
    v_add_f32 v26, v18, v19
    v_add_f32 v27, v20, v21
    v_add_f32 v26, v26, v27
    v_mov_b32 v27, v26
    v_and_b32 v36, v5, v22
    v_and_b32 v37, v6, v22
    v_and_b32 v38, v7, v22
    v_and_b32 v39, v8, v22
    v_permlane16_swap_b32 v26, v27
    v_add_f32 v26, v26, v27
    v_mov_b32 v27, v26
    v_and_b32 v40, v5, v23
    v_and_b32 v41, v6, v23
    v_and_b32 v42, v7, v23
    v_and_b32 v43, v8, v23
    v_permlane32_swap_b32 v26, v27
    v_add_f32 v26, v26, v27
    v_add_f32 v31, v31, v26
    v_and_b32 v44, v5, v24
    v_and_b32 v45, v6, v24
    v_and_b32 v46, v7, v24
    v_and_b32 v47, v8, v24
    ds_write_b64 v9, v[30:31]
    v_and_b32 v48, v5, v25
    v_and_b32 v49, v6, v25
    v_and_b32 v50, v7, v25
    v_and_b32 v51, v8, v25
    s_nop 0
    s_waitcnt vmcnt(7)
    v_mfma_f32_16x16x32_bf16 v[32:35], v[36:39], v[68:71], v[32:35]
    buffer_load_dwordx4 v[68:71], v1, s[40:43], s45 offen offset:0 nt
    s_waitcnt vmcnt(7)
    v_mfma_f32_16x16x32_bf16 v[32:35], v[40:43], v[72:75], v[32:35]
    buffer_load_dwordx4 v[72:75], v1, s[40:43], s45 offen offset:1024 nt
    s_waitcnt vmcnt(7)
    v_mfma_f32_16x16x32_bf16 v[32:35], v[44:47], v[76:79], v[32:35]
    buffer_load_dwordx4 v[76:79], v1, s[40:43], s45 offen offset:2048 nt
    s_waitcnt vmcnt(7)
    v_mfma_f32_16x16x32_bf16 v[32:35], v[48:51], v[80:83], v[32:35]
    buffer_load_dwordx4 v[80:83], v1, s[40:43], s45 offen offset:3072 nt
    s_cmp_lt_u32 s49, 5
    s_cbranch_scc1 L_bsel
    s_add_u32 s49, s49, 1
    s_cmp_lg_u32 s38, 0
    s_cbranch_scc1 L_sloop
L_sfin:
    s_nop 3
    ds_write_b128 v4, v[32:35] offset:3072
    s_mov_b64 exec, 1
    ds_add_u32 v2, v3 offset:3008
    s_endpgm
L_scont:
    s_add_u32 s49, s49, 1
    s_cmp_lg_u32 s38, 0
    s_cbranch_scc1 L_sloop
    s_cmp_ge_u32 s49, 5
    s_cbranch_scc1 L_sfin
L_bsel:
    s_cmp_eq_u32 s49, 1
    s_cbranch_scc1 L_back1
    s_cmp_eq_u32 s49, 2
    s_cbranch_scc1 L_back2
    s_cmp_eq_u32 s49, 3
    s_cbranch_scc1 L_back3
    s_cmp_eq_u32 s49, 4
    s_cbranch_scc1 L_back4
L_back0:
    v_dot2_f32_bf16 v18, v84, v10, 0
    v_dot2_f32_bf16 v22, v84, v14, 0
    v_dot2_f32_bf16 v18, v85, v11, v18
    v_dot2_f32_bf16 v22, v85, v15, v22
    v_dot2_f32_bf16 v18, v86, v12, v18
    v_dot2_f32_bf16 v22, v86, v16, v22
    v_dot2_f32_bf16 v18, v87, v13, v18
    v_dot2_f32_bf16 v22, v87, v17, v22
    v_dot2_f32_bf16 v19, v88, v10, 0
    v_dot2_f32_bf16 v23, v88, v14, 0
    v_dot2_f32_bf16 v19, v89, v11, v19
    v_dot2_f32_bf16 v23, v89, v15, v23
    v_dot2_f32_bf16 v19, v90, v12, v19
    v_dot2_f32_bf16 v23, v90, v16, v23
    v_dot2_f32_bf16 v19, v91, v13, v19
    v_dot2_f32_bf16 v23, v91, v17, v23
    v_dot2_f32_bf16 v20, v92, v10, 0
    v_dot2_f32_bf16 v24, v92, v14, 0
    v_dot2_f32_bf16 v20, v93, v11, v20
    v_dot2_f32_bf16 v24, v93, v15, v24
    v_dot2_f32_bf16 v20, v94, v12, v20
    v_dot2_f32_bf16 v24, v94, v16, v24
    v_dot2_f32_bf16 v20, v95, v13, v20
    v_dot2_f32_bf16 v24, v95, v17, v24
    v_dot2_f32_bf16 v21, v96, v10, 0
    v_dot2_f32_bf16 v25, v96, v14, 0
    v_dot2_f32_bf16 v21, v97, v11, v21
    v_dot2_f32_bf16 v25, v97, v15, v25
    v_dot2_f32_bf16 v21, v98, v12, v21
    v_dot2_f32_bf16 v25, v98, v16, v25
    v_dot2_f32_bf16 v21, v99, v13, v21
    v_dot2_f32_bf16 v25, v99, v17, v25
    v_add_f32_dpp v18, v18, v18 row_ror:8 row_mask:0xf bank_mask:0x3
    v_add_f32_dpp v19, v19, v19 row_ror:8 row_mask:0xf bank_mask:0x3
    v_add_f32_dpp v20, v20, v20 row_ror:8 row_mask:0xf bank_mask:0x3
    v_add_f32_dpp v21, v21, v21 row_ror:8 row_mask:0xf bank_mask:0x3
    v_add_f32_dpp v18, v22, v22 row_ror:8 row_mask:0xf bank_mask:0xc
    v_add_f32_dpp v19, v23, v23 row_ror:8 row_mask:0xf bank_mask:0xc
    v_add_f32_dpp v20, v24, v24 row_ror:8 row_mask:0xf bank_mask:0xc
    v_add_f32_dpp v21, v25, v25 row_ror:8 row_mask:0xf bank_mask:0xc
    v_add_f32_dpp v18, v18, v18 row_half_mirror row_mask:0xf bank_mask:0xf
    v_add_f32_dpp v19, v19, v19 row_half_mirror row_mask:0xf bank_mask:0xf
    v_add_f32_dpp v20, v20, v20 row_half_mirror row_mask:0xf bank_mask:0xf
    v_add_f32_dpp v21, v21, v21 row_half_mirror row_mask:0xf bank_mask:0xf
    v_add_f32_dpp v18, v18, v18 quad_perm:[1,0,3,2] row_mask:0xf bank_mask:0xf
    v_add_f32_dpp v19, v19, v19 quad_perm:[1,0,3,2] row_mask:0xf bank_mask:0xf
    v_add_f32_dpp v20, v20, v20 quad_perm:[1,0,3,2] row_mask:0xf bank_mask:0xf
    v_add_f32_dpp v21, v21, v21 quad_perm:[1,0,3,2] row_mask:0xf bank_mask:0xf
    v_add_f32_dpp v18, v18, v18 quad_perm:[2,3,0,1] row_mask:0xf bank_mask:0xf
    v_add_f32_dpp v19, v19, v19 quad_perm:[2,3,0,1] row_mask:0xf bank_mask:0xf
    v_add_f32_dpp v20, v20, v20 quad_perm:[2,3,0,1] row_mask:0xf bank_mask:0xf
    v_add_f32_dpp v21, v21, v21 quad_perm:[2,3,0,1] row_mask:0xf bank_mask:0xf
    v_cvt_pk_bf16_f32 v26, v18, v19
    v_cvt_pk_bf16_f32 v27, v20, v21
    v_lshlrev_b32 v18, 16, v26
    v_and_b32 v19, s46, v26
    v_lshlrev_b32 v20, 16, v27
    v_and_b32 v21, s46, v27
    v_mul_f32 v18, s47, v18
    v_mul_f32 v19, s47, v19
    v_mul_f32 v20, s47, v20
    v_mul_f32 v21, s47, v21
    v_cvt_pk_bf16_f32 v26, v18, v19
    v_cvt_pk_bf16_f32 v27, v20, v21
    v_lshlrev_b32 v18, 16, v26
    v_and_b32 v19, s46, v26
    v_lshlrev_b32 v20, 16, v27
    v_and_b32 v21, s46, v27
    v_max3_f32 v28, v18, v19, v20
    v_max_f32 v28, v28, v21
    v_cmp_gt_f32 vcc, v28, v29
    s_cbranch_vccz L_nors_3
    s_call_b64 s[50:51], L_rescale
L_nors_3:
    v_fma_f32 v18, v18, s48, -v30
    v_fma_f32 v19, v19, s48, -v30
    v_fma_f32 v20, v20, s48, -v30
    v_fma_f32 v21, v21, s48, -v30
    v_exp_f32 v18, v18
    v_exp_f32 v19, v19
    v_exp_f32 v20, v20
    v_exp_f32 v21, v21
    s_nop 0
    v_cvt_pk_bf16_f32 v22, v18, v18
    v_cvt_pk_bf16_f32 v23, v19, v19
    v_cvt_pk_bf16_f32 v24, v20, v20
    v_cvt_pk_bf16_f32 v25, v21, v21
    v_add_f32 v26, v18, v19
    v_add_f32 v27, v20, v21
    v_add_f32 v26, v26, v27
    v_mov_b32 v27, v26
    v_and_b32 v36, v5, v22
    v_and_b32 v37, v6, v22
    v_and_b32 v38, v7, v22
    v_and_b32 v39, v8, v22
    v_permlane16_swap_b32 v26, v27
    v_add_f32 v26, v26, v27
    v_mov_b32 v27, v26
    v_and_b32 v40, v5, v23
    v_and_b32 v41, v6, v23
    v_and_b32 v42, v7, v23
    v_and_b32 v43, v8, v23
    v_permlane32_swap_b32 v26, v27
    v_add_f32 v26, v26, v27
    v_add_f32 v31, v31, v26
    v_and_b32 v44, v5, v24
    v_and_b32 v45, v6, v24
    v_and_b32 v46, v7, v24
    v_and_b32 v47, v8, v24
    ds_write_b64 v9, v[30:31]
    v_and_b32 v48, v5, v25
    v_and_b32 v49, v6, v25
    v_and_b32 v50, v7, v25
    v_and_b32 v51, v8, v25
    s_nop 0
    v_mfma_f32_16x16x32_bf16 v[32:35], v[36:39], v[100:103], v[32:35]
    v_mfma_f32_16x16x32_bf16 v[32:35], v[40:43], v[104:107], v[32:35]
    v_mfma_f32_16x16x32_bf16 v[32:35], v[44:47], v[108:111], v[32:35]
    v_mfma_f32_16x16x32_bf16 v[32:35], v[48:51], v[112:115], v[32:35]
    s_branch L_scont
L_back1:
    v_dot2_f32_bf16 v18, v116, v10, 0
    v_dot2_f32_bf16 v22, v116, v14, 0
    v_dot2_f32_bf16 v18, v117, v11, v18
    v_dot2_f32_bf16 v22, v117, v15, v22
    v_dot2_f32_bf16 v18, v118, v12, v18
    v_dot2_f32_bf16 v22, v118, v16, v22
    v_dot2_f32_bf16 v18, v119, v13, v18
    v_dot2_f32_bf16 v22, v119, v17, v22
    v_dot2_f32_bf16 v19, v120, v10, 0
    v_dot2_f32_bf16 v23, v120, v14, 0
    v_dot2_f32_bf16 v19, v121, v11, v19
    v_dot2_f32_bf16 v23, v121, v15, v23
    v_dot2_f32_bf16 v19, v122, v12, v19
    v_dot2_f32_bf16 v23, v122, v16, v23
    v_dot2_f32_bf16 v19, v123, v13, v19
    v_dot2_f32_bf16 v23, v123, v17, v23
    v_dot2_f32_bf16 v20, v124, v10, 0
    v_dot2_f32_bf16 v24, v124, v14, 0
    v_dot2_f32_bf16 v20, v125, v11, v20
    v_dot2_f32_bf16 v24, v125, v15, v24
    v_dot2_f32_bf16 v20, v126, v12, v20
    v_dot2_f32_bf16 v24, v126, v16, v24
    v_dot2_f32_bf16 v20, v127, v13, v20
    v_dot2_f32_bf16 v24, v127, v17, v24
    v_dot2_f32_bf16 v21, v128, v10, 0
    v_dot2_f32_bf16 v25, v128, v14, 0
    v_dot2_f32_bf16 v21, v129, v11, v21
    v_dot2_f32_bf16 v25, v129, v15, v25
    v_dot2_f32_bf16 v21, v130, v12, v21
    v_dot2_f32_bf16 v25, v130, v16, v25
    v_dot2_f32_bf16 v21, v131, v13, v21
    v_dot2_f32_bf16 v25, v131, v17, v25
    v_add_f32_dpp v18, v18, v18 row_ror:8 row_mask:0xf bank_mask:0x3
    v_add_f32_dpp v19, v19, v19 row_ror:8 row_mask:0xf bank_mask:0x3
    v_add_f32_dpp v20, v20, v20 row_ror:8 row_mask:0xf bank_mask:0x3
    v_add_f32_dpp v21, v21, v21 row_ror:8 row_mask:0xf bank_mask:0x3
    v_add_f32_dpp v18, v22, v22 row_ror:8 row_mask:0xf bank_mask:0xc
    v_add_f32_dpp v19, v23, v23 row_ror:8 row_mask:0xf bank_mask:0xc
    v_add_f32_dpp v20, v24, v24 row_ror:8 row_mask:0xf bank_mask:0xc
    v_add_f32_dpp v21, v25, v25 row_ror:8 row_mask:0xf bank_mask:0xc
    v_add_f32_dpp v18, v18, v18 row_half_mirror row_mask:0xf bank_mask:0xf
    v_add_f32_dpp v19, v19, v19 row_half_mirror row_mask:0xf bank_mask:0xf
    v_add_f32_dpp v20, v20, v20 row_half_mirror row_mask:0xf bank_mask:0xf
    v_add_f32_dpp v21, v21, v21 row_half_mirror row_mask:0xf bank_mask:0xf
    v_add_f32_dpp v18, v18, v18 quad_perm:[1,0,3,2] row_mask:0xf bank_mask:0xf
    v_add_f32_dpp v19, v19, v19 quad_perm:[1,0,3,2] row_mask:0xf bank_mask:0xf
    v_add_f32_dpp v20, v20, v20 quad_perm:[1,0,3,2] row_mask:0xf bank_mask:0xf
    v_add_f32_dpp v21, v21, v21 quad_perm:[1,0,3,2] row_mask:0xf bank_mask:0xf
    v_add_f32_dpp v18, v18, v18 quad_perm:[2,3,0,1] row_mask:0xf bank_mask:0xf
    v_add_f32_dpp v19, v19, v19 quad_perm:[2,3,0,1] row_mask:0xf bank_mask:0xf
    v_add_f32_dpp v20, v20, v20 quad_perm:[2,3,0,1] row_mask:0xf bank_mask:0xf
    v_add_f32_dpp v21, v21, v21 quad_perm:[2,3,0,1] row_mask:0xf bank_mask:0xf
    v_cvt_pk_bf16_f32 v26, v18, v19
    v_cvt_pk_bf16_f32 v27, v20, v21
    v_lshlrev_b32 v18, 16, v26
    v_and_b32 v19, s46, v26
    v_lshlrev_b32 v20, 16, v27
    v_and_b32 v21, s46, v27
    v_mul_f32 v18, s47, v18
    v_mul_f32 v19, s47, v19
    v_mul_f32 v20, s47, v20
    v_mul_f32 v21, s47, v21
    v_cvt_pk_bf16_f32 v26, v18, v19
    v_cvt_pk_bf16_f32 v27, v20, v21
    v_lshlrev_b32 v18, 16, v26
    v_and_b32 v19, s46, v26
    v_lshlrev_b32 v20, 16, v27
    v_and_b32 v21, s46, v27
    v_max3_f32 v28, v18, v19, v20
    v_max_f32 v28, v28, v21
    v_cmp_gt_f32 vcc, v28, v29
    s_cbranch_vccz L_nors_4
    s_call_b64 s[50:51], L_rescale
L_nors_4:
    v_fma_f32 v18, v18, s48, -v30
    v_fma_f32 v19, v19, s48, -v30
    v_fma_f32 v20, v20, s48, -v30
    v_fma_f32 v21, v21, s48, -v30
    v_exp_f32 v18, v18
    v_exp_f32 v19, v19
    v_exp_f32 v20, v20
    v_exp_f32 v21, v21
    s_nop 0
    v_cvt_pk_bf16_f32 v22, v18, v18
    v_cvt_pk_bf16_f32 v23, v19, v19
    v_cvt_pk_bf16_f32 v24, v20, v20
    v_cvt_pk_bf16_f32 v25, v21, v21
    v_add_f32 v26, v18, v19
    v_add_f32 v27, v20, v21
    v_add_f32 v26, v26, v27
    v_mov_b32 v27, v26
    v_and_b32 v36, v5, v22
    v_and_b32 v37, v6, v22
    v_and_b32 v38, v7, v22
    v_and_b32 v39, v8, v22
    v_permlane16_swap_b32 v26, v27
    v_add_f32 v26, v26, v27
    v_mov_b32 v27, v26
    v_and_b32 v40, v5, v23
    v_and_b32 v41, v6, v23
    v_and_b32 v42, v7, v23
    v_and_b32 v43, v8, v23
    v_permlane32_swap_b32 v26, v27
    v_add_f32 v26, v26, v27
    v_add_f32 v31, v31, v26
    v_and_b32 v44, v5, v24
    v_and_b32 v45, v6, v24
    v_and_b32 v46, v7, v24
    v_and_b32 v47, v8, v24
    ds_write_b64 v9, v[30:31]
    v_and_b32 v48, v5, v25
    v_and_b32 v49, v6, v25
    v_and_b32 v50, v7, v25
    v_and_b32 v51, v8, v25
    s_nop 0
    v_mfma_f32_16x16x32_bf16 v[32:35], v[36:39], v[132:135], v[32:35]
    v_mfma_f32_16x16x32_bf16 v[32:35], v[40:43], v[136:139], v[32:35]
    v_mfma_f32_16x16x32_bf16 v[32:35], v[44:47], v[140:143], v[32:35]
    v_mfma_f32_16x16x32_bf16 v[32:35], v[48:51], v[144:147], v[32:35]
    s_branch L_scont
L_back2:
    v_dot2_f32_bf16 v18, v148, v10, 0
    v_dot2_f32_bf16 v22, v148, v14, 0
    v_dot2_f32_bf16 v18, v149, v11, v18
    v_dot2_f32_bf16 v22, v149, v15, v22
    v_dot2_f32_bf16 v18, v150, v12, v18
    v_dot2_f32_bf16 v22, v150, v16, v22
    v_dot2_f32_bf16 v18, v151, v13, v18
    v_dot2_f32_bf16 v22, v151, v17, v22
    v_dot2_f32_bf16 v19, v152, v10, 0
    v_dot2_f32_bf16 v23, v152, v14, 0
    v_dot2_f32_bf16 v19, v153, v11, v19
    v_dot2_f32_bf16 v23, v153, v15, v23
    v_dot2_f32_bf16 v19, v154, v12, v19
    v_dot2_f32_bf16 v23, v154, v16, v23
    v_dot2_f32_bf16 v19, v155, v13, v19
    v_dot2_f32_bf16 v23, v155, v17, v23
    v_dot2_f32_bf16 v20, v156, v10, 0
    v_dot2_f32_bf16 v24, v156, v14, 0
    v_dot2_f32_bf16 v20, v157, v11, v20
    v_dot2_f32_bf16 v24, v157, v15, v24
    v_dot2_f32_bf16 v20, v158, v12, v20
    v_dot2_f32_bf16 v24, v158, v16, v24
    v_dot2_f32_bf16 v20, v159, v13, v20
    v_dot2_f32_bf16 v24, v159, v17, v24
    v_dot2_f32_bf16 v21, v160, v10, 0
    v_dot2_f32_bf16 v25, v160, v14, 0
    v_dot2_f32_bf16 v21, v161, v11, v21
    v_dot2_f32_bf16 v25, v161, v15, v25
    v_dot2_f32_bf16 v21, v162, v12, v21
    v_dot2_f32_bf16 v25, v162, v16, v25
    v_dot2_f32_bf16 v21, v163, v13, v21
    v_dot2_f32_bf16 v25, v163, v17, v25
    v_add_f32_dpp v18, v18, v18 row_ror:8 row_mask:0xf bank_mask:0x3
    v_add_f32_dpp v19, v19, v19 row_ror:8 row_mask:0xf bank_mask:0x3
    v_add_f32_dpp v20, v20, v20 row_ror:8 row_mask:0xf bank_mask:0x3
    v_add_f32_dpp v21, v21, v21 row_ror:8 row_mask:0xf bank_mask:0x3
    v_add_f32_dpp v18, v22, v22 row_ror:8 row_mask:0xf bank_mask:0xc
    v_add_f32_dpp v19, v23, v23 row_ror:8 row_mask:0xf bank_mask:0xc
    v_add_f32_dpp v20, v24, v24 row_ror:8 row_mask:0xf bank_mask:0xc
    v_add_f32_dpp v21, v25, v25 row_ror:8 row_mask:0xf bank_mask:0xc
    v_add_f32_dpp v18, v18, v18 row_half_mirror row_mask:0xf bank_mask:0xf
    v_add_f32_dpp v19, v19, v19 row_half_mirror row_mask:0xf bank_mask:0xf
    v_add_f32_dpp v20, v20, v20 row_half_mirror row_mask:0xf bank_mask:0xf
    v_add_f32_dpp v21, v21, v21 row_half_mirror row_mask:0xf bank_mask:0xf
    v_add_f32_dpp v18, v18, v18 quad_perm:[1,0,3,2] row_mask:0xf bank_mask:0xf
    v_add_f32_dpp v19, v19, v19 quad_perm:[1,0,3,2] row_mask:0xf bank_mask:0xf
    v_add_f32_dpp v20, v20, v20 quad_perm:[1,0,3,2] row_mask:0xf bank_mask:0xf
    v_add_f32_dpp v21, v21, v21 quad_perm:[1,0,3,2] row_mask:0xf bank_mask:0xf
    v_add_f32_dpp v18, v18, v18 quad_perm:[2,3,0,1] row_mask:0xf bank_mask:0xf
    v_add_f32_dpp v19, v19, v19 quad_perm:[2,3,0,1] row_mask:0xf bank_mask:0xf
    v_add_f32_dpp v20, v20, v20 quad_perm:[2,3,0,1] row_mask:0xf bank_mask:0xf
    v_add_f32_dpp v21, v21, v21 quad_perm:[2,3,0,1] row_mask:0xf bank_mask:0xf
    v_cvt_pk_bf16_f32 v26, v18, v19
    v_cvt_pk_bf16_f32 v27, v20, v21
    v_lshlrev_b32 v18, 16, v26
    v_and_b32 v19, s46, v26
    v_lshlrev_b32 v20, 16, v27
    v_and_b32 v21, s46, v27
    v_mul_f32 v18, s47, v18
    v_mul_f32 v19, s47, v19
    v_mul_f32 v20, s47, v20
    v_mul_f32 v21, s47, v21
    v_cvt_pk_bf16_f32 v26, v18, v19
    v_cvt_pk_bf16_f32 v27, v20, v21
    v_lshlrev_b32 v18, 16, v26
    v_and_b32 v19, s46, v26
    v_lshlrev_b32 v20, 16, v27
    v_and_b32 v21, s46, v27
    v_max3_f32 v28, v18, v19, v20
    v_max_f32 v28, v28, v21
    v_cmp_gt_f32 vcc, v28, v29
    s_cbranch_vccz L_nors_5
    s_call_b64 s[50:51], L_rescale
L_nors_5:
    v_fma_f32 v18, v18, s48, -v30
    v_fma_f32 v19, v19, s48, -v30
    v_fma_f32 v20, v20, s48, -v30
    v_fma_f32 v21, v21, s48, -v30
    v_exp_f32 v18, v18
    v_exp_f32 v19, v19
    v_exp_f32 v20, v20
    v_exp_f32 v21, v21
    s_nop 0
    v_cvt_pk_bf16_f32 v22, v18, v18
    v_cvt_pk_bf16_f32 v23, v19, v19
    v_cvt_pk_bf16_f32 v24, v20, v20
    v_cvt_pk_bf16_f32 v25, v21, v21
    v_add_f32 v26, v18, v19
    v_add_f32 v27, v20, v21
    v_add_f32 v26, v26, v27
    v_mov_b32 v27, v26
    v_and_b32 v36, v5, v22
    v_and_b32 v37, v6, v22
    v_and_b32 v38, v7, v22
    v_and_b32 v39, v8, v22
    v_permlane16_swap_b32 v26, v27
    v_add_f32 v26, v26, v27
    v_mov_b32 v27, v26
    v_and_b32 v40, v5, v23
    v_and_b32 v41, v6, v23
    v_and_b32 v42, v7, v23
    v_and_b32 v43, v8, v23
    v_permlane32_swap_b32 v26, v27
    v_add_f32 v26, v26, v27
    v_add_f32 v31, v31, v26
    v_and_b32 v44, v5, v24
    v_and_b32 v45, v6, v24
    v_and_b32 v46, v7, v24
    v_and_b32 v47, v8, v24
    ds_write_b64 v9, v[30:31]
    v_and_b32 v48, v5, v25
    v_and_b32 v49, v6, v25
    v_and_b32 v50, v7, v25
    v_and_b32 v51, v8, v25
    s_nop 0
    v_mfma_f32_16x16x32_bf16 v[32:35], v[36:39], v[164:167], v[32:35]
    v_mfma_f32_16x16x32_bf16 v[32:35], v[40:43], v[168:171], v[32:35]
    v_mfma_f32_16x16x32_bf16 v[32:35], v[44:47], v[172:175], v[32:35]
    v_mfma_f32_16x16x32_bf16 v[32:35], v[48:51], v[176:179], v[32:35]
    s_branch L_scont
L_back3:
    v_dot2_f32_bf16 v18, v180, v10, 0
    v_dot2_f32_bf16 v22, v180, v14, 0
    v_dot2_f32_bf16 v18, v181, v11, v18
    v_dot2_f32_bf16 v22, v181, v15, v22
    v_dot2_f32_bf16 v18, v182, v12, v18
    v_dot2_f32_bf16 v22, v182, v16, v22
    v_dot2_f32_bf16 v18, v183, v13, v18
    v_dot2_f32_bf16 v22, v183, v17, v22
    v_dot2_f32_bf16 v19, v184, v10, 0
    v_dot2_f32_bf16 v23, v184, v14, 0
    v_dot2_f32_bf16 v19, v185, v11, v19
    v_dot2_f32_bf16 v23, v185, v15, v23
    v_dot2_f32_bf16 v19, v186, v12, v19
    v_dot2_f32_bf16 v23, v186, v16, v23
    v_dot2_f32_bf16 v19, v187, v13, v19
    v_dot2_f32_bf16 v23, v187, v17, v23
    v_dot2_f32_bf16 v20, v188, v10, 0
    v_dot2_f32_bf16 v24, v188, v14, 0
    v_dot2_f32_bf16 v20, v189, v11, v20
    v_dot2_f32_bf16 v24, v189, v15, v24
    v_dot2_f32_bf16 v20, v190, v12, v20
    v_dot2_f32_bf16 v24, v190, v16, v24
    v_dot2_f32_bf16 v20, v191, v13, v20
    v_dot2_f32_bf16 v24, v191, v17, v24
    v_dot2_f32_bf16 v21, v192, v10, 0
    v_dot2_f32_bf16 v25, v192, v14, 0
    v_dot2_f32_bf16 v21, v193, v11, v21
    v_dot2_f32_bf16 v25, v193, v15, v25
    v_dot2_f32_bf16 v21, v194, v12, v21
    v_dot2_f32_bf16 v25, v194, v16, v25
    v_dot2_f32_bf16 v21, v195, v13, v21
    v_dot2_f32_bf16 v25, v195, v17, v25
    v_add_f32_dpp v18, v18, v18 row_ror:8 row_mask:0xf bank_mask:0x3
    v_add_f32_dpp v19, v19, v19 row_ror:8 row_mask:0xf bank_mask:0x3
    v_add_f32_dpp v20, v20, v20 row_ror:8 row_mask:0xf bank_mask:0x3
    v_add_f32_dpp v21, v21, v21 row_ror:8 row_mask:0xf bank_mask:0x3
    v_add_f32_dpp v18, v22, v22 row_ror:8 row_mask:0xf bank_mask:0xc
    v_add_f32_dpp v19, v23, v23 row_ror:8 row_mask:0xf bank_mask:0xc
    v_add_f32_dpp v20, v24, v24 row_ror:8 row_mask:0xf bank_mask:0xc
    v_add_f32_dpp v21, v25, v25 row_ror:8 row_mask:0xf bank_mask:0xc
    v_add_f32_dpp v18, v18, v18 row_half_mirror row_mask:0xf bank_mask:0xf
    v_add_f32_dpp v19, v19, v19 row_half_mirror row_mask:0xf bank_mask:0xf
    v_add_f32_dpp v20, v20, v20 row_half_mirror row_mask:0xf bank_mask:0xf
    v_add_f32_dpp v21, v21, v21 row_half_mirror row_mask:0xf bank_mask:0xf
    v_add_f32_dpp v18, v18, v18 quad_perm:[1,0,3,2] row_mask:0xf bank_mask:0xf
    v_add_f32_dpp v19, v19, v19 quad_perm:[1,0,3,2] row_mask:0xf bank_mask:0xf
    v_add_f32_dpp v20, v20, v20 quad_perm:[1,0,3,2] row_mask:0xf bank_mask:0xf
    v_add_f32_dpp v21, v21, v21 quad_perm:[1,0,3,2] row_mask:0xf bank_mask:0xf
    v_add_f32_dpp v18, v18, v18 quad_perm:[2,3,0,1] row_mask:0xf bank_mask:0xf
    v_add_f32_dpp v19, v19, v19 quad_perm:[2,3,0,1] row_mask:0xf bank_mask:0xf
    v_add_f32_dpp v20, v20, v20 quad_perm:[2,3,0,1] row_mask:0xf bank_mask:0xf
    v_add_f32_dpp v21, v21, v21 quad_perm:[2,3,0,1] row_mask:0xf bank_mask:0xf
    v_cvt_pk_bf16_f32 v26, v18, v19
    v_cvt_pk_bf16_f32 v27, v20, v21
    v_lshlrev_b32 v18, 16, v26
    v_and_b32 v19, s46, v26
    v_lshlrev_b32 v20, 16, v27
    v_and_b32 v21, s46, v27
    v_mul_f32 v18, s47, v18
    v_mul_f32 v19, s47, v19
    v_mul_f32 v20, s47, v20
    v_mul_f32 v21, s47, v21
    v_cvt_pk_bf16_f32 v26, v18, v19
    v_cvt_pk_bf16_f32 v27, v20, v21
    v_lshlrev_b32 v18, 16, v26
    v_and_b32 v19, s46, v26
    v_lshlrev_b32 v20, 16, v27
    v_and_b32 v21, s46, v27
    v_max3_f32 v28, v18, v19, v20
    v_max_f32 v28, v28, v21
    v_cmp_gt_f32 vcc, v28, v29
    s_cbranch_vccz L_nors_6
    s_call_b64 s[50:51], L_rescale
L_nors_6:
    v_fma_f32 v18, v18, s48, -v30
    v_fma_f32 v19, v19, s48, -v30
    v_fma_f32 v20, v20, s48, -v30
    v_fma_f32 v21, v21, s48, -v30
    v_exp_f32 v18, v18
    v_exp_f32 v19, v19
    v_exp_f32 v20, v20
    v_exp_f32 v21, v21
    s_nop 0
    v_cvt_pk_bf16_f32 v22, v18, v18
    v_cvt_pk_bf16_f32 v23, v19, v19
    v_cvt_pk_bf16_f32 v24, v20, v20
    v_cvt_pk_bf16_f32 v25, v21, v21
    v_add_f32 v26, v18, v19
    v_add_f32 v27, v20, v21
    v_add_f32 v26, v26, v27
    v_mov_b32 v27, v26
    v_and_b32 v36, v5, v22
    v_and_b32 v37, v6, v22
    v_and_b32 v38, v7, v22
    v_and_b32 v39, v8, v22
    v_permlane16_swap_b32 v26, v27
    v_add_f32 v26, v26, v27
    v_mov_b32 v27, v26
    v_and_b32 v40, v5, v23
    v_and_b32 v41, v6, v23
    v_and_b32 v42, v7, v23
    v_and_b32 v43, v8, v23
    v_permlane32_swap_b32 v26, v27
    v_add_f32 v26, v26, v27
    v_add_f32 v31, v31, v26
    v_and_b32 v44, v5, v24
    v_and_b32 v45, v6, v24
    v_and_b32 v46, v7, v24
    v_and_b32 v47, v8, v24
    ds_write_b64 v9, v[30:31]
    v_and_b32 v48, v5, v25
    v_and_b32 v49, v6, v25
    v_and_b32 v50, v7, v25
    v_and_b32 v51, v8, v25
    s_nop 0
    v_mfma_f32_16x16x32_bf16 v[32:35], v[36:39], v[196:199], v[32:35]
    v_mfma_f32_16x16x32_bf16 v[32:35], v[40:43], v[200:203], v[32:35]
    v_mfma_f32_16x16x32_bf16 v[32:35], v[44:47], v[204:207], v[32:35]
    v_mfma_f32_16x16x32_bf16 v[32:35], v[48:51], v[208:211], v[32:35]
    s_branch L_scont
L_back4:
    v_dot2_f32_bf16 v18, v212, v10, 0
    v_dot2_f32_bf16 v22, v212, v14, 0
    v_dot2_f32_bf16 v18, v213, v11, v18
    v_dot2_f32_bf16 v22, v213, v15, v22
    v_dot2_f32_bf16 v18, v214, v12, v18
    v_dot2_f32_bf16 v22, v214, v16, v22
    v_dot2_f32_bf16 v18, v215, v13, v18
    v_dot2_f32_bf16 v22, v215, v17, v22
    v_dot2_f32_bf16 v19, v216, v10, 0
    v_dot2_f32_bf16 v23, v216, v14, 0
    v_dot2_f32_bf16 v19, v217, v11, v19
    v_dot2_f32_bf16 v23, v217, v15, v23
    v_dot2_f32_bf16 v19, v218, v12, v19
    v_dot2_f32_bf16 v23, v218, v16, v23
    v_dot2_f32_bf16 v19, v219, v13, v19
    v_dot2_f32_bf16 v23, v219, v17, v23
    v_dot2_f32_bf16 v20, v220, v10, 0
    v_dot2_f32_bf16 v24, v220, v14, 0
    v_dot2_f32_bf16 v20, v221, v11, v20
    v_dot2_f32_bf16 v24, v221, v15, v24
    v_dot2_f32_bf16 v20, v222, v12, v20
    v_dot2_f32_bf16 v24, v222, v16, v24
    v_dot2_f32_bf16 v20, v223, v13, v20
    v_dot2_f32_bf16 v24, v223, v17, v24
    v_dot2_f32_bf16 v21, v224, v10, 0
    v_dot2_f32_bf16 v25, v224, v14, 0
    v_dot2_f32_bf16 v21, v225, v11, v21
    v_dot2_f32_bf16 v25, v225, v15, v25
    v_dot2_f32_bf16 v21, v226, v12, v21
    v_dot2_f32_bf16 v25, v226, v16, v25
    v_dot2_f32_bf16 v21, v227, v13, v21
    v_dot2_f32_bf16 v25, v227, v17, v25
    v_add_f32_dpp v18, v18, v18 row_ror:8 row_mask:0xf bank_mask:0x3
    v_add_f32_dpp v19, v19, v19 row_ror:8 row_mask:0xf bank_mask:0x3
    v_add_f32_dpp v20, v20, v20 row_ror:8 row_mask:0xf bank_mask:0x3
    v_add_f32_dpp v21, v21, v21 row_ror:8 row_mask:0xf bank_mask:0x3
    v_add_f32_dpp v18, v22, v22 row_ror:8 row_mask:0xf bank_mask:0xc
    v_add_f32_dpp v19, v23, v23 row_ror:8 row_mask:0xf bank_mask:0xc
    v_add_f32_dpp v20, v24, v24 row_ror:8 row_mask:0xf bank_mask:0xc
    v_add_f32_dpp v21, v25, v25 row_ror:8 row_mask:0xf bank_mask:0xc
    v_add_f32_dpp v18, v18, v18 row_half_mirror row_mask:0xf bank_mask:0xf
    v_add_f32_dpp v19, v19, v19 row_half_mirror row_mask:0xf bank_mask:0xf
    v_add_f32_dpp v20, v20, v20 row_half_mirror row_mask:0xf bank_mask:0xf
    v_add_f32_dpp v21, v21, v21 row_half_mirror row_mask:0xf bank_mask:0xf
    v_add_f32_dpp v18, v18, v18 quad_perm:[1,0,3,2] row_mask:0xf bank_mask:0xf
    v_add_f32_dpp v19, v19, v19 quad_perm:[1,0,3,2] row_mask:0xf bank_mask:0xf
    v_add_f32_dpp v20, v20, v20 quad_perm:[1,0,3,2] row_mask:0xf bank_mask:0xf
    v_add_f32_dpp v21, v21, v21 quad_perm:[1,0,3,2] row_mask:0xf bank_mask:0xf
    v_add_f32_dpp v18, v18, v18 quad_perm:[2,3,0,1] row_mask:0xf bank_mask:0xf
    v_add_f32_dpp v19, v19, v19 quad_perm:[2,3,0,1] row_mask:0xf bank_mask:0xf
    v_add_f32_dpp v20, v20, v20 quad_perm:[2,3,0,1] row_mask:0xf bank_mask:0xf
    v_add_f32_dpp v21, v21, v21 quad_perm:[2,3,0,1] row_mask:0xf bank_mask:0xf
    v_cvt_pk_bf16_f32 v26, v18, v19
    v_cvt_pk_bf16_f32 v27, v20, v21
    v_lshlrev_b32 v18, 16, v26
    v_and_b32 v19, s46, v26
    v_lshlrev_b32 v20, 16, v27
    v_and_b32 v21, s46, v27
    v_mul_f32 v18, s47, v18
    v_mul_f32 v19, s47, v19
    v_mul_f32 v20, s47, v20
    v_mul_f32 v21, s47, v21
    v_cvt_pk_bf16_f32 v26, v18, v19
    v_cvt_pk_bf16_f32 v27, v20, v21
    v_lshlrev_b32 v18, 16, v26
    v_and_b32 v19, s46, v26
    v_lshlrev_b32 v20, 16, v27
    v_and_b32 v21, s46, v27
    v_max3_f32 v28, v18, v19, v20
    v_max_f32 v28, v28, v21
    v_cmp_gt_f32 vcc, v28, v29
    s_cbranch_vccz L_nors_7
    s_call_b64 s[50:51], L_rescale
L_nors_7:
    v_fma_f32 v18, v18, s48, -v30
    v_fma_f32 v19, v19, s48, -v30
    v_fma_f32 v20, v20, s48, -v30
    v_fma_f32 v21, v21, s48, -v30
    v_exp_f32 v18, v18
    v_exp_f32 v19, v19
    v_exp_f32 v20, v20
    v_exp_f32 v21, v21
    s_nop 0
    v_cvt_pk_bf16_f32 v22, v18, v18
    v_cvt_pk_bf16_f32 v23, v19, v19
    v_cvt_pk_bf16_f32 v24, v20, v20
    v_cvt_pk_bf16_f32 v25, v21, v21
    v_add_f32 v26, v18, v19
    v_add_f32 v27, v20, v21
    v_add_f32 v26, v26, v27
    v_mov_b32 v27, v26
    v_and_b32 v36, v5, v22
    v_and_b32 v37, v6, v22
    v_and_b32 v38, v7, v22
    v_and_b32 v39, v8, v22
    v_permlane16_swap_b32 v26, v27
    v_add_f32 v26, v26, v27
    v_mov_b32 v27, v26
    v_and_b32 v40, v5, v23
    v_and_b32 v41, v6, v23
    v_and_b32 v42, v7, v23
    v_and_b32 v43, v8, v23
    v_permlane32_swap_b32 v26, v27
    v_add_f32 v26, v26, v27
    v_add_f32 v31, v31, v26
    v_and_b32 v44, v5, v24
    v_and_b32 v45, v6, v24
    v_and_b32 v46, v7, v24
    v_and_b32 v47, v8, v24
    ds_write_b64 v9, v[30:31]
    v_and_b32 v48, v5, v25
    v_and_b32 v49, v6, v25
    v_and_b32 v50, v7, v25
    v_and_b32 v51, v8, v25
    s_nop 0
    v_mfma_f32_16x16x32_bf16 v[32:35], v[36:39], v[228:231], v[32:35]
    v_mfma_f32_16x16x32_bf16 v[32:35], v[40:43], v[232:235], v[32:35]
    v_mfma_f32_16x16x32_bf16 v[32:35], v[44:47], v[236:239], v[32:35]
    v_mfma_f32_16x16x32_bf16 v[32:35], v[48:51], v[240:243], v[32:35]
    s_branch L_scont
L_rescale:
    v_max_f32 v28, v28, v29
    v_mov_b32 v26, v28
    s_nop 1
    v_permlane16_swap_b32 v28, v26
    s_nop 0
    v_max_f32 v28, v28, v26
    v_mov_b32 v26, v28
    s_nop 1
    v_permlane32_swap_b32 v28, v26
    s_nop 0
    v_max_f32 v28, v28, v26
    v_mov_b32 v29, v28
    v_mul_f32 v27, s48, v28
    v_sub_f32 v26, v30, v27
    v_exp_f32 v26, v26
    v_mov_b32 v30, v27
    v_mul_f32 v31, v31, v26
    v_readlane_b32 s63, v26, 0
    v_readlane_b32 s56, v26, 8
    s_nop 1
    v_mov_b32 v26, s63
    v_mov_b32 v27, s56
    v_cndmask_b32 v26, v26, v27, s[52:53]
    v_mul_f32 v32, v32, v26
    v_mul_f32 v33, v33, v26
    v_mul_f32 v34, v34, v26
    v_mul_f32 v35, v35, v26
    s_setpc_b64 s[50:51]
L_service:
    s_setprio 2
    v_and_b32 v1, 15, v0
    v_lshrrev_b32 v2, 4, v0
    s_cmp_lg_u32 s3, 0
    s_cbranch_scc1 L_svc_other
    v_lshrrev_b32 v3, 5, v0
    v_mul_u32_u24 v3, 1152, v3
    v_and_b32 v4, 31, v0
    v_lshl_add_u32 v3, v4, 2, v3
    v_mov_b32 v6, 0
    s_lshr_b32 s46, s2, 3
    s_and_b32 s47, s46, 15
    s_lshr_b32 s48, s46, 4
    s_bfe_u32 s49, s2, 0x10002
    s_lshl_b32 s44, s48, 1
    s_add_u32 s49, s49, s44
    s_and_b32 s50, s2, 3
    s_waitcnt lgkmcnt(0)
    s_mov_b32 s36, s4
    s_mov_b32 s37, s5
    s_mov_b32 s38, 0x900
    s_mov_b32 s39, 0x20000
    s_mov_b32 s28, s26
    s_mov_b32 s29, s27
    s_mov_b32 s30, 0x10000000
    s_mov_b32 s31, 0x20000
    buffer_load_dword v17, v3, s[36:39], 0 offen offset:0
    buffer_load_dword v19, v3, s[36:39], 0 offen offset:128
    buffer_load_dword v21, v3, s[36:39], 0 offen offset:256
    buffer_load_dword v23, v3, s[36:39], 0 offen offset:384
    buffer_load_dword v25, v3, s[36:39], 0 offen offset:512
    buffer_load_dword v27, v3, s[36:39], 0 offen offset:640
    buffer_load_dword v29, v3, s[36:39], 0 offen offset:768
    buffer_load_dword v31, v3, s[36:39], 0 offen offset:896
    buffer_load_dword v33, v3, s[36:39], 0 offen offset:1024
    buffer_load_dword v7, v6, s[28:31], 0 offen offset:0 sc1
    s_mov_b32 s32, s24
    s_mov_b32 s33, s25
    s_mov_b32 s34, 0x100
    s_mov_b32 s35, 0x20000
    s_and_b32 s44, s2, 7
    s_cmp_eq_u32 s44, 0
    s_cselect_b64 exec, 1, 0
    s_lshl_b32 s44, s46, 8
    s_add_u32 s44, s44, 0x1000
    buffer_store_dword v6, v6, s[28:31], s44 offen sc1
    buffer_store_dword v6, v6, s[28:31], s44 offen offset:128 sc1
    s_mov_b64 exec, -1
    s_mov_b32 s40, 0xffff0000
    s_barrier
    s_waitcnt vmcnt(0)
    v_lshlrev_b32 v16, 16, v17
    v_and_b32 v17, s40, v17
    v_lshlrev_b32 v18, 16, v19
    v_and_b32 v19, s40, v19
    v_lshlrev_b32 v20, 16, v21
    v_and_b32 v21, s40, v21
    v_lshlrev_b32 v22, 16, v23
    v_and_b32 v23, s40, v23
    v_lshlrev_b32 v24, 16, v25
    v_and_b32 v25, s40, v25
    v_lshlrev_b32 v26, 16, v27
    v_and_b32 v27, s40, v27
    v_lshlrev_b32 v28, 16, v29
    v_and_b32 v29, s40, v29
    v_lshlrev_b32 v30, 16, v31
    v_and_b32 v31, s40, v31
    v_lshlrev_b32 v32, 16, v33
    v_and_b32 v33, s40, v33
    v_add_u32 v7, 0x9e3779b9, v7
    v_add_u32 v8, 512, v3
    v_add_f32 v40, v16, v17
    v_add_f32 v41, v18, v19
    v_add_f32 v40, v40, v20
    v_add_f32 v41, v41, v21
    v_add_f32 v40, v40, v22
    v_add_f32 v41, v41, v23
    v_add_f32 v40, v40, v24
    v_add_f32 v41, v41, v25
    v_add_f32 v40, v40, v26
    v_add_f32 v41, v41, v27
    v_add_f32 v40, v40, v28
    v_add_f32 v41, v41, v29
    v_add_f32 v40, v40, v30
    v_add_f32 v41, v41, v31
    v_add_f32 v40, v40, v32
    v_add_f32 v41, v41, v33
    v_add_f32 v40, v40, v41
    s_nop 1
    v_add_f32_dpp v40, v40, v40 row_ror:8 row_mask:0xf bank_mask:0xf
    s_nop 1
    v_add_f32_dpp v40, v40, v40 row_ror:4 row_mask:0xf bank_mask:0xf
    s_nop 1
    v_add_f32_dpp v40, v40, v40 row_ror:2 row_mask:0xf bank_mask:0xf
    s_nop 1
    v_add_f32_dpp v40, v40, v40 row_ror:1 row_mask:0xf bank_mask:0xf
    v_mov_b32 v41, v40
    s_nop 1
    v_permlane16_swap_b32 v40, v41
    s_nop 0
    v_add_f32 v40, v40, v41
    v_mul_f32 v42, 0x3ae38e39, v40
    v_lshrrev_b32 v43, 5, v0
    v_lshlrev_b32 v43, 2, v43
    ds_write_b32 v43, v42 offset:2816
    v_sub_f32 v44, v16, v42
    v_sub_f32 v45, v17, v42
    v_sub_f32 v46, v18, v42
    v_sub_f32 v47, v19, v42
    v_sub_f32 v48, v20, v42
    v_sub_f32 v49, v21, v42
    v_sub_f32 v50, v22, v42
    v_sub_f32 v51, v23, v42
    v_sub_f32 v52, v24, v42
    v_sub_f32 v53, v25, v42
    v_sub_f32 v54, v26, v42
    v_sub_f32 v55, v27, v42
    v_sub_f32 v56, v28, v42
    v_sub_f32 v57, v29, v42
    v_sub_f32 v58, v30, v42
    v_sub_f32 v59, v31, v42
    v_sub_f32 v60, v32, v42
    v_sub_f32 v61, v33, v42
    v_mul_f32 v40, v44, v44
    v_mul_f32 v41, v45, v45
    v_fmac_f32 v40, v46, v46
    v_fmac_f32 v41, v47, v47
    v_fmac_f32 v40, v48, v48
    v_fmac_f32 v41, v49, v49
    v_fmac_f32 v40, v50, v50
    v_fmac_f32 v41, v51, v51
    v_fmac_f32 v40, v52, v52
    v_fmac_f32 v41, v53, v53
    v_fmac_f32 v40, v54, v54
    v_fmac_f32 v41, v55, v55
    v_fmac_f32 v40, v56, v56
    v_fmac_f32 v41, v57, v57
    v_fmac_f32 v40, v58, v58
    v_fmac_f32 v41, v59, v59
    v_fmac_f32 v40, v60, v60
    v_fmac_f32 v41, v61, v61
    v_add_f32 v40, v40, v41
    s_nop 1
    v_add_f32_dpp v40, v40, v40 row_ror:8 row_mask:0xf bank_mask:0xf
    s_nop 1
    v_add_f32_dpp v40, v40, v40 row_ror:4 row_mask:0xf bank_mask:0xf
    s_nop 1
    v_add_f32_dpp v40, v40, v40 row_ror:2 row_mask:0xf bank_mask:0xf
    s_nop 1
    v_add_f32_dpp v40, v40, v40 row_ror:1 row_mask:0xf bank_mask:0xf
    v_mov_b32 v41, v40
    s_nop 1
    v_permlane16_swap_b32 v40, v41
    s_nop 0
    v_add_f32 v40, v40, v41
    v_mul_f32 v40, 0x3ae38e39, v40
    v_cvt_pk_bf16_f32 v41, v42, v40
    s_mov_b32 s40, 0xffff0000
    v_lshlrev_b32 v42, 16, v41
    v_and_b32 v40, s40, v41
    v_add_f32 v40, 0x3727c5ac, v40
    v_cvt_pk_bf16_f32 v40, v40, v40
    v_and_b32 v40, s40, v40
    v_sqrt_f32 v40, v40
    s_nop 0
    v_cvt_pk_bf16_f32 v40, v40, v40
    v_and_b32 v40, s40, v40
    v_rcp_f32 v43, v40
    v_sub_f32 v44, v16, v42
    v_sub_f32 v45, v17, v42
    v_sub_f32 v46, v18, v42
    v_sub_f32 v47, v19, v42
    v_sub_f32 v48, v20, v42
    v_sub_f32 v49, v21, v42
    v_sub_f32 v50, v22, v42
    v_sub_f32 v51, v23, v42
    v_sub_f32 v52, v24, v42
    v_sub_f32 v53, v25, v42
    v_sub_f32 v54, v26, v42
    v_sub_f32 v55, v27, v42
    v_sub_f32 v56, v28, v42
    v_sub_f32 v57, v29, v42
    v_sub_f32 v58, v30, v42
    v_sub_f32 v59, v31, v42
    v_sub_f32 v60, v32, v42
    v_sub_f32 v61, v33, v42
    v_cvt_pk_bf16_f32 v45, v44, v45
    v_cvt_pk_bf16_f32 v47, v46, v47
    v_cvt_pk_bf16_f32 v49, v48, v49
    v_cvt_pk_bf16_f32 v51, v50, v51
    v_cvt_pk_bf16_f32 v53, v52, v53
    v_cvt_pk_bf16_f32 v55, v54, v55
    v_cvt_pk_bf16_f32 v57, v56, v57
    v_cvt_pk_bf16_f32 v59, v58, v59
    v_cvt_pk_bf16_f32 v61, v60, v61
    v_lshlrev_b32 v44, 16, v45
    v_and_b32 v45, s40, v45
    v_lshlrev_b32 v46, 16, v47
    v_and_b32 v47, s40, v47
    v_lshlrev_b32 v48, 16, v49
    v_and_b32 v49, s40, v49
    v_lshlrev_b32 v50, 16, v51
    v_and_b32 v51, s40, v51
    v_lshlrev_b32 v52, 16, v53
    v_and_b32 v53, s40, v53
    v_lshlrev_b32 v54, 16, v55
    v_and_b32 v55, s40, v55
    v_lshlrev_b32 v56, 16, v57
    v_and_b32 v57, s40, v57
    v_lshlrev_b32 v58, 16, v59
    v_and_b32 v59, s40, v59
    v_lshlrev_b32 v60, 16, v61
    v_and_b32 v61, s40, v61
    v_mul_f32 v44, v44, v43
    v_mul_f32 v45, v45, v43
    v_mul_f32 v46, v46, v43
    v_mul_f32 v47, v47, v43
    v_mul_f32 v48, v48, v43
    v_mul_f32 v49, v49, v43
    v_mul_f32 v50, v50, v43
    v_mul_f32 v51, v51, v43
    v_mul_f32 v52, v52, v43
    v_mul_f32 v53, v53, v43
    v_mul_f32 v54, v54, v43
    v_mul_f32 v55, v55, v43
    v_mul_f32 v56, v56, v43
    v_mul_f32 v57, v57, v43
    v_mul_f32 v58, v58, v43
    v_mul_f32 v59, v59, v43
    v_mul_f32 v60, v60, v43
    v_mul_f32 v61, v61, v43
    v_cvt_pk_bf16_f32 v44, v44, v45
    v_cvt_pk_bf16_f32 v46, v46, v47
    v_cvt_pk_bf16_f32 v48, v48, v49
    v_cvt_pk_bf16_f32 v50, v50, v51
    v_cvt_pk_bf16_f32 v52, v52, v53
    v_cvt_pk_bf16_f32 v54, v54, v55
    v_cvt_pk_bf16_f32 v56, v56, v57
    v_cvt_pk_bf16_f32 v58, v58, v59
    v_cvt_pk_bf16_f32 v60, v60, v61
    ds_write_b32 v8, v44 offset:0
    ds_write_b32 v8, v46 offset:128
    ds_write_b32 v8, v48 offset:256
    ds_write_b32 v8, v50 offset:384
    ds_write_b32 v8, v52 offset:512
    ds_write_b32 v8, v54 offset:640
    ds_write_b32 v8, v56 offset:768
    ds_write_b32 v8, v58 offset:896
    ds_write_b32 v8, v60 offset:1024
    v_and_b32 v9, 1, v0
    v_mul_u32_u24 v9, 1152, v9
    v_lshl_add_u32 v9, v2, 3, v9
    s_mul_i32 s44, s50, 288
    v_add_u32 v9, s44, v9
    v_lshrrev_b32 v10, 2, v0
    v_lshlrev_b32 v10, 7, v10
    v_and_b32 v11, 3, v0
    v_lshl_add_u32 v10, v11, 3, v10
    s_waitcnt lgkmcnt(0)
    ds_read_b64 v[64:65], v9 offset:512
    ds_read_b64 v[66:67], v9 offset:544
    ds_read_b64 v[68:69], v9 offset:576
    ds_read_b64 v[70:71], v9 offset:608
    ds_read_b64 v[72:73], v9 offset:640
    ds_read_b64 v[74:75], v9 offset:672
    ds_read_b64 v[76:77], v9 offset:704
    ds_read_b64 v[78:79], v9 offset:736
    ds_read_b64 v[80:81], v9 offset:768
    v_mov_b32 v12, 0
    s_mov_b32 s60, 0
L_lw_8:
    ds_read_b32 v13, v12 offset:3016
    s_waitcnt lgkmcnt(0)
    v_cmp_le_u32 vcc, 3, v13
    s_add_u32 s60, s60, 1
    s_cmp_gt_u32 s60, 4000000
    s_cbranch_scc1 L_lw_8_x
    s_cbranch_vccnz L_lw_8_x
    s_branch L_lw_8
L_lw_8_x:
    ds_read_b64_tr_b16 v[84:85], v10 offset:8192
    ds_read_b64_tr_b16 v[86:87], v10 offset:8224
    ds_read_b64_tr_b16 v[88:89], v10 offset:8256
    ds_read_b64_tr_b16 v[90:91], v10 offset:8288
    ds_read_b64_tr_b16 v[92:93], v10 offset:10240
    ds_read_b64_tr_b16 v[94:95], v10 offset:10272
    ds_read_b64_tr_b16 v[96:97], v10 offset:10304
    ds_read_b64_tr_b16 v[98:99], v10 offset:10336
    ds_read_b64_tr_b16 v[100:101], v10 offset:12288
    ds_read_b64_tr_b16 v[102:103], v10 offset:12320
    ds_read_b64_tr_b16 v[104:105], v10 offset:12352
    ds_read_b64_tr_b16 v[106:107], v10 offset:12384
    s_waitcnt lgkmcnt(0)
    v_mfma_f32_16x16x16_bf16 v[160:163], v[84:85], v[64:65], 0
    v_mfma_f32_16x16x16_bf16 v[164:167], v[86:87], v[64:65], 0
    v_mfma_f32_16x16x16_bf16 v[168:171], v[88:89], v[64:65], 0
    v_mfma_f32_16x16x16_bf16 v[172:175], v[90:91], v[64:65], 0
    v_mfma_f32_16x16x16_bf16 v[160:163], v[92:93], v[66:67], v[160:163]
    v_mfma_f32_16x16x16_bf16 v[164:167], v[94:95], v[66:67], v[164:167]
    v_mfma_f32_16x16x16_bf16 v[168:171], v[96:97], v[66:67], v[168:171]
    v_mfma_f32_16x16x16_bf16 v[172:175], v[98:99], v[66:67], v[172:175]
    v_mfma_f32_16x16x16_bf16 v[160:163], v[100:101], v[68:69], v[160:163]
    v_mfma_f32_16x16x16_bf16 v[164:167], v[102:103], v[68:69], v[164:167]
    v_mfma_f32_16x16x16_bf16 v[168:171], v[104:105], v[68:69], v[168:171]
    v_mfma_f32_16x16x16_bf16 v[172:175], v[106:107], v[68:69], v[172:175]
    ds_read_b64_tr_b16 v[108:109], v10 offset:14336
    ds_read_b64_tr_b16 v[110:111], v10 offset:14368
    ds_read_b64_tr_b16 v[112:113], v10 offset:14400
    ds_read_b64_tr_b16 v[114:115], v10 offset:14432
    ds_read_b64_tr_b16 v[116:117], v10 offset:16384
    ds_read_b64_tr_b16 v[118:119], v10 offset:16416
    ds_read_b64_tr_b16 v[120:121], v10 offset:16448
    ds_read_b64_tr_b16 v[122:123], v10 offset:16480
    ds_read_b64_tr_b16 v[124:125], v10 offset:18432
    ds_read_b64_tr_b16 v[126:127], v10 offset:18464
    ds_read_b64_tr_b16 v[128:129], v10 offset:18496
    ds_read_b64_tr_b16 v[130:131], v10 offset:18528
    s_waitcnt lgkmcnt(0)
    v_mfma_f32_16x16x16_bf16 v[160:163], v[108:109], v[70:71], v[160:163]
    v_mfma_f32_16x16x16_bf16 v[164:167], v[110:111], v[70:71], v[164:167]
    v_mfma_f32_16x16x16_bf16 v[168:171], v[112:113], v[70:71], v[168:171]
    v_mfma_f32_16x16x16_bf16 v[172:175], v[114:115], v[70:71], v[172:175]
    v_mfma_f32_16x16x16_bf16 v[160:163], v[116:117], v[72:73], v[160:163]
    v_mfma_f32_16x16x16_bf16 v[164:167], v[118:119], v[72:73], v[164:167]
    v_mfma_f32_16x16x16_bf16 v[168:171], v[120:121], v[72:73], v[168:171]
    v_mfma_f32_16x16x16_bf16 v[172:175], v[122:123], v[72:73], v[172:175]
    v_mfma_f32_16x16x16_bf16 v[160:163], v[124:125], v[74:75], v[160:163]
    v_mfma_f32_16x16x16_bf16 v[164:167], v[126:127], v[74:75], v[164:167]
    v_mfma_f32_16x16x16_bf16 v[168:171], v[128:129], v[74:75], v[168:171]
    v_mfma_f32_16x16x16_bf16 v[172:175], v[130:131], v[74:75], v[172:175]
    ds_read_b64_tr_b16 v[132:133], v10 offset:20480
    ds_read_b64_tr_b16 v[134:135], v10 offset:20512
    ds_read_b64_tr_b16 v[136:137], v10 offset:20544
    ds_read_b64_tr_b16 v[138:139], v10 offset:20576
    ds_read_b64_tr_b16 v[140:141], v10 offset:22528
    ds_read_b64_tr_b16 v[142:143], v10 offset:22560
    ds_read_b64_tr_b16 v[144:145], v10 offset:22592
    ds_read_b64_tr_b16 v[146:147], v10 offset:22624
    ds_read_b64_tr_b16 v[148:149], v10 offset:24576
    ds_read_b64_tr_b16 v[150:151], v10 offset:24608
    ds_read_b64_tr_b16 v[152:153], v10 offset:24640
    ds_read_b64_tr_b16 v[154:155], v10 offset:24672
    s_waitcnt lgkmcnt(0)
    v_mfma_f32_16x16x16_bf16 v[160:163], v[132:133], v[76:77], v[160:163]
    v_mfma_f32_16x16x16_bf16 v[164:167], v[134:135], v[76:77], v[164:167]
    v_mfma_f32_16x16x16_bf16 v[168:171], v[136:137], v[76:77], v[168:171]
    v_mfma_f32_16x16x16_bf16 v[172:175], v[138:139], v[76:77], v[172:175]
    v_mfma_f32_16x16x16_bf16 v[160:163], v[140:141], v[78:79], v[160:163]
    v_mfma_f32_16x16x16_bf16 v[164:167], v[142:143], v[78:79], v[164:167]
    v_mfma_f32_16x16x16_bf16 v[168:171], v[144:145], v[78:79], v[168:171]
    v_mfma_f32_16x16x16_bf16 v[172:175], v[146:147], v[78:79], v[172:175]
    v_mfma_f32_16x16x16_bf16 v[160:163], v[148:149], v[80:81], v[160:163]
    v_mfma_f32_16x16x16_bf16 v[164:167], v[150:151], v[80:81], v[164:167]
    v_mfma_f32_16x16x16_bf16 v[168:171], v[152:153], v[80:81], v[168:171]
    v_mfma_f32_16x16x16_bf16 v[172:175], v[154:155], v[80:81], v[172:175]
    s_lshl_b32 s45, s47, 14
    s_lshl_b32 s44, s50, 11
    s_add_u32 s45, s45, s44
    s_lshl_b32 s44, s49, 9
    s_add_u32 s45, s45, s44
    s_add_u32 s45, s45, 0x180000
    v_and_b32 v10, 1, v0
    v_lshlrev_b32 v10, 13, v10
    v_lshl_add_u32 v10, v2, 5, v10
    v_bfe_u32 v11, v0, 1, 1
    v_lshl_add_u32 v10, v11, 4, v10
    v_cmp_eq_u32 vcc, 1, v11
    s_mov_b32 s52, 0x000f000f
    s_mov_b32 s53, 0x000f000f
    v_mov_b32 v17, v7
    v_mov_b32 v19, v7
    v_mov_b32 v21, v7
    v_mov_b32 v23, v7
    v_mov_b32 v25, v7
    v_mov_b32 v27, v7
    v_mov_b32 v29, v7
    v_mov_b32 v31, v7
    v_cndmask_b32 v16, v160, v162, vcc
    v_cndmask_b32 v18, v161, v163, vcc
    v_cndmask_b32 v20, v164, v166, vcc
    v_cndmask_b32 v22, v165, v167, vcc
    v_cndmask_b32 v24, v168, v170, vcc
    v_cndmask_b32 v26, v169, v171, vcc
    v_cndmask_b32 v28, v172, v174, vcc
    v_cndmask_b32 v30, v173, v175, vcc
    s_mov_b64 exec, s[52:53]
    buffer_store_dwordx4 v[16:19], v10, s[28:31], s45 offen offset:0 sc1
    buffer_store_dwordx4 v[20:23], v10, s[28:31], s45 offen offset:128 sc1
    buffer_store_dwordx4 v[24:27], v10, s[28:31], s45 offen offset:256 sc1
    buffer_store_dwordx4 v[28:31], v10, s[28:31], s45 offen offset:384 sc1
    s_getreg_b32 s44, hwreg(HW_REG_XCC_ID)
    s_and_b32 s45, s2, 7
    s_lshl_b32 s45, s45, 5
    s_add_u32 s45, s45, s46
    s_lshl_b32 s45, s45, 3
    s_add_u32 s45, s45, 0x4000
    s_mov_b64 exec, 1
    v_mov_b32 v32, s44
    v_mov_b32 v33, v7
    buffer_store_dwordx2 v[32:33], v6, s[28:31], s45 offen sc1
    s_mov_b64 exec, -1
    s_lshl_b32 s44, s47, 1
    s_add_u32 s44, s44, s48
    s_lshl_b32 s44, s44, 13
    s_add_u32 s44, s44, 0x180000
    s_add_u32 s45, s44, 4096
    v_lshlrev_b32 v10, 4, v0
    v_lshlrev_b32 v11, 2, v0
    v_mov_b32 v12, 0
    s_mov_b32 s60, 0
L_lw_9:
    ds_read_b32 v13, v12 offset:3020
    s_waitcnt lgkmcnt(0)
    v_cmp_le_u32 vcc, 1, v13
    s_add_u32 s60, s60, 1
    s_cmp_gt_u32 s60, 4000000
    s_cbranch_scc1 L_lw_9_x
    s_cbranch_vccnz L_lw_9_x
    s_sleep 2
    s_branch L_lw_9
L_lw_9_x:
    s_mov_b32 s60, 0
L_qpoll:
    buffer_load_dwordx4 v[64:67], v10, s[28:31], s44 offen offset:0 sc1
    buffer_load_dwordx4 v[68:71], v10, s[28:31], s44 offen offset:1024 sc1
    buffer_load_dwordx4 v[72:75], v10, s[28:31], s44 offen offset:2048 sc1
    buffer_load_dwordx4 v[76:79], v10, s[28:31], s44 offen offset:3072 sc1
    buffer_load_dwordx4 v[80:83], v10, s[28:31], s45 offen offset:0 sc1
    buffer_load_dwordx4 v[84:87], v10, s[28:31], s45 offen offset:1024 sc1
    buffer_load_dwordx4 v[88:91], v10, s[28:31], s45 offen offset:2048 sc1
    buffer_load_dwordx4 v[92:95], v10, s[28:31], s45 offen offset:3072 sc1
    s_waitcnt vmcnt(0)
    v_xor_b32 v65, v65, v7
    v_xor_b32 v67, v67, v7
    v_xor_b32 v69, v69, v7
    v_xor_b32 v71, v71, v7
    v_xor_b32 v73, v73, v7
    v_xor_b32 v75, v75, v7
    v_xor_b32 v77, v77, v7
    v_xor_b32 v79, v79, v7
    v_xor_b32 v81, v81, v7
    v_xor_b32 v83, v83, v7
    v_xor_b32 v85, v85, v7
    v_xor_b32 v87, v87, v7
    v_xor_b32 v89, v89, v7
    v_xor_b32 v91, v91, v7
    v_xor_b32 v93, v93, v7
    v_xor_b32 v95, v95, v7
    v_or_b32 v12, v65, v67
    v_or3_b32 v12, v12, v69, v71
    v_or3_b32 v12, v12, v73, v75
    v_or3_b32 v12, v12, v77, v79
    v_or3_b32 v12, v12, v81, v83
    v_or3_b32 v12, v12, v85, v87
    v_or3_b32 v12, v12, v89, v91
    v_or3_b32 v12, v12, v93, v95
    v_cmp_ne_u32 vcc, 0, v12
    s_add_u32 s60, s60, 1
    s_cmp_gt_u32 s60, 200000
    s_cbranch_scc1 L_qpoll_x
    s_cbranch_vccnz L_qpoll
L_qpoll_x:
    v_add_f32 v64, v64, v72
    v_add_f32 v80, v80, v88
    v_add_f32 v66, v66, v74
    v_add_f32 v82, v82, v90
    v_add_f32 v68, v68, v76
    v_add_f32 v84, v84, v92
    v_add_f32 v70, v70, v78
    v_add_f32 v86, v86, v94
    v_add_f32 v64, v64, v80
    v_add_f32 v66, v66, v82
    v_add_f32 v68, v68, v84
    v_add_f32 v70, v70, v86
    v_cvt_pk_bf16_f32 v12, v64, v66
    v_cvt_pk_bf16_f32 v13, v68, v70
    ds_write_b32 v11, v12 offset:0
    ds_write_b32 v11, v13 offset:256
    v_mov_b32 v12, 1
    ds_write_b32 v6, v12 offset:3028
    v_readfirstlane_b32 s61, v7
    s_waitcnt lgkmcnt(0)
    s_branch L_svc_a
L_svc_other:
    v_lshrrev_b32 v4, 3, v0
    v_lshlrev_b32 v4, 13, v4
    v_and_b32 v5, 7, v0
    v_lshl_add_u32 v4, v5, 4, v4
    s_bfe_u32 s47, s2, 0x40003
    s_lshr_b32 s48, s2, 7
    s_bfe_u32 s49, s2, 0x10002
    s_lshl_b32 s44, s48, 1
    s_add_u32 s49, s49, s44
    s_and_b32 s50, s2, 3
    s_lshl_b32 s45, s47, 2
    s_add_u32 s45, s45, s49
    s_lshl_b32 s45, s45, 7
    s_mul_i32 s44, s50, 3
    s_add_u32 s44, s44, s3
    s_sub_u32 s44, s44, 1
    s_mul_i32 s44, s44, 393216
    s_add_u32 s45, s45, s44
    s_mul_i32 s46, s3, 6144
    s_add_u32 s46, s46, 2048
    s_waitcnt lgkmcnt(0)
    s_mov_b32 s40, s10
    s_mov_b32 s41, s11
    s_mov_b32 s42, 0x480000
    s_mov_b32 s43, 0x20000
    s_mov_b32 m0, s46
    s_add_u32 s46, s46, 1024
    buffer_load_dwordx4 v4, s[40:43], s45 offen nt lds
    s_add_u32 s45, s45, 65536
    s_mov_b32 m0, s46
    s_add_u32 s46, s46, 1024
    buffer_load_dwordx4 v4, s[40:43], s45 offen nt lds
    s_add_u32 s45, s45, 65536
    s_mov_b32 m0, s46
    s_add_u32 s46, s46, 1024
    buffer_load_dwordx4 v4, s[40:43], s45 offen nt lds
    s_add_u32 s45, s45, 65536
    s_mov_b32 m0, s46
    s_add_u32 s46, s46, 1024
    buffer_load_dwordx4 v4, s[40:43], s45 offen nt lds
    s_add_u32 s45, s45, 65536
    s_mov_b32 m0, s46
    s_add_u32 s46, s46, 1024
    buffer_load_dwordx4 v4, s[40:43], s45 offen nt lds
    s_add_u32 s45, s45, 65536
    s_mov_b32 m0, s46
    s_add_u32 s46, s46, 1024
    buffer_load_dwordx4 v4, s[40:43], s45 offen nt lds
    s_add_u32 s45, s45, 65536
    s_mov_b32 s28, s26
    s_mov_b32 s29, s27
    s_mov_b32 s30, 0x10000000
    s_mov_b32 s31, 0x20000
    s_mov_b32 s32, s24
    s_mov_b32 s33, s25
    s_mov_b32 s34, 0x100
    s_mov_b32 s35, 0x20000
    s_mov_b32 s61, 0
    v_mov_b32 v6, 0
    v_mov_b32 v7, 1
    s_barrier
    s_waitcnt vmcnt(0)
    s_mov_b64 exec, 1
    ds_add_u32 v6, v7 offset:3016
    s_mov_b64 exec, -1
    v_mov_b32 v12, 0
    s_mov_b32 s60, 0
L_lw_10:
    ds_read_b32 v13, v12 offset:3016
    s_waitcnt lgkmcnt(0)
    v_cmp_le_u32 vcc, 1, v13
    s_add_u32 s60, s60, 1
    s_cmp_gt_u32 s60, 4000000
    s_cbranch_scc1 L_lw_10_x
    s_cbranch_vccnz L_lw_10_x
    s_sleep 4
    s_branch L_lw_10
L_lw_10_x:
L_svc_a:
    s_and_b32 s44, s2, 7
    s_lshr_b32 s45, s2, 3
    s_add_u32 s46, s44, s45
    s_and_b32 s46, s46, 7
    s_lshr_b32 s47, s45, 3
    s_lshl_b32 s59, s46, 5
    s_add_u32 s59, s59, s45
    s_lshl_b32 s48, s46, 2
    s_add_u32 s48, s48, s47
    s_cmp_ge_u32 s46, 2
    s_cbranch_scc1 L_r_n
    s_mul_i32 s97, s44, 9
    s_add_u32 s97, s97, s48
    s_add_u32 s97, s97, 6
    s_cmp_lt_u32 s48, 3
    s_cselect_b32 s58, 1, 0
    s_mov_b32 s62, 0
    s_mov_b32 s63, 0
    s_branch L_role
L_r_n:
    s_sub_u32 s48, s48, 8
    s_lshr_b32 s62, s48, 1
    s_and_b32 s63, s48, 1
    s_lshl_b32 s49, s44, 1
    s_add_u32 s63, s63, s49
    s_mul_i32 s97, s44, 9
    s_add_u32 s97, s97, s48
    s_sub_u32 s97, s97, 18
    s_cmp_lt_u32 s48, 18
    s_cselect_b32 s58, 2, 3
    s_cmp_lg_u32 s3, 1
    s_cbranch_scc1 L_role
    v_mov_b32 v10, 0
    v_mov_b32 v4, -1
    v_mov_b32 v5, -1
    v_mov_b32 v6, -1
    v_mov_b32 v7, -1
    v_lshlrev_b32 v8, 4, v0
    s_mul_i32 s44, s44, 24
    s_add_u32 s44, s44, s48
    s_lshl_b32 s44, s44, 12
    s_add_u32 s44, s44, 0x10000
    buffer_store_dwordx4 v[4:7], v8, s[28:31], s44 offen offset:0 sc1
    buffer_store_dwordx4 v[4:7], v8, s[28:31], s44 offen offset:1024 sc1
    buffer_store_dwordx4 v[4:7], v8, s[28:31], s44 offen offset:2048 sc1
    buffer_store_dwordx4 v[4:7], v8, s[28:31], s44 offen offset:3072 sc1
    v_mov_b32 v9, 1
    s_waitcnt vmcnt(0)
    s_mov_b64 exec, 1
    buffer_atomic_add v9, v10, s[32:35], 0 offen
    s_mov_b64 exec, -1
    s_branch L_role
L_box:
    v_mov_b32 v12, -1
    v_mov_b32 v13, -1
    v_mov_b32 v14, -1
    v_mov_b32 v15, -1
    v_lshlrev_b32 v8, 4, v0
    v_mov_b32 v9, 0
    v_mov_b32 v7, 1
    s_cmp_eq_u32 s53, 0
    s_cbranch_scc1 L_box_x
    s_cmp_eq_u32 s49, 0
    s_cbranch_scc1 L_box_l
    s_mov_b64 exec, 1
    ds_add_u32 v9, v7 offset:3008
    s_mov_b64 exec, -1
    v_mov_b32 v7, 0
    v_mov_b32 v10, 0
    s_mov_b32 s60, 0
L_lw_11:
    ds_read_b32 v11, v10 offset:3012
    s_waitcnt lgkmcnt(0)
    v_cmp_le_u32 vcc, 4, v11
    s_add_u32 s60, s60, 1
    s_cmp_gt_u32 s60, 4000000
    s_cbranch_scc1 L_lw_11_x
    s_cbranch_vccnz L_lw_11_x
    s_sleep 2
    s_branch L_lw_11
L_lw_11_x:
L_box_l:
    buffer_store_dwordx4 v[12:15], v8, s[28:31], s52 offen sc1
    buffer_store_dwordx4 v[12:15], v8, s[28:31], s52 offen offset:1024 sc1
    s_mov_b64 exec, 0xffff
    buffer_store_dwordx4 v[12:15], v8, s[28:31], s52 offen offset:2048 sc1
    s_mov_b64 exec, -1
    s_add_u32 s52, s52, s53
    buffer_store_dwordx4 v[12:15], v8, s[28:31], s52 offen sc1
    buffer_store_dwordx4 v[12:15], v8, s[28:31], s52 offen offset:1024 sc1
    s_mov_b64 exec, 0xffff
    buffer_store_dwordx4 v[12:15], v8, s[28:31], s52 offen offset:2048 sc1
    s_mov_b64 exec, -1
    s_add_u32 s52, s52, s53
    buffer_store_dwordx4 v[12:15], v8, s[28:31], s52 offen sc1
    buffer_store_dwordx4 v[12:15], v8, s[28:31], s52 offen offset:1024 sc1
    s_mov_b64 exec, 0xffff
    buffer_store_dwordx4 v[12:15], v8, s[28:31], s52 offen offset:2048 sc1
    s_mov_b64 exec, -1
    s_add_u32 s52, s52, s53
    buffer_store_dwordx4 v[12:15], v8, s[28:31], s52 offen sc1
    buffer_store_dwordx4 v[12:15], v8, s[28:31], s52 offen offset:1024 sc1
    s_mov_b64 exec, 0xffff
    buffer_store_dwordx4 v[12:15], v8, s[28:31], s52 offen offset:2048 sc1
    s_mov_b64 exec, -1
    s_add_u32 s52, s52, s53
L_box_x:
    s_waitcnt vmcnt(0)
    s_mov_b64 exec, 1
    ds_add_u32 v9, v7 offset:3008
    s_mov_b64 exec, -1
    s_setpc_b64 s[50:51]
L_finish:
    v_mov_b32 v4, 0
    s_mov_b32 s60, 0
L_lw_12:
    ds_read_b32 v5, v4 offset:3024
    s_waitcnt lgkmcnt(0)
    v_cmp_le_u32 vcc, 1, v5
    s_add_u32 s60, s60, 1
    s_cmp_gt_u32 s60, 4000000
    s_cbranch_scc1 L_lw_12_x
    s_cbranch_vccnz L_lw_12_x
    s_sleep 8
    s_branch L_lw_12
L_lw_12_x:
    s_getreg_b32 s44, hwreg(HW_REG_XCC_ID)
    s_and_b32 s45, s2, 7
    s_lshl_b32 s45, s45, 8
    s_add_u32 s45, s45, 0x4000
    v_mov_b32 v4, 0
    v_and_b32 v5, 31, v0
    v_lshlrev_b32 v5, 3, v5
    s_mov_b32 s60, 0
L_rpoll:
    buffer_load_dword v8, v4, s[32:35], 0 offen sc1
    buffer_load_dwordx2 v[6:7], v5, s[28:31], s45 offen sc1
    s_waitcnt vmcnt(0)
    v_cmp_gt_u32 vcc, 192, v8
    s_add_u32 s60, s60, 1
    s_cmp_gt_u32 s60, 200000
    s_cbranch_scc1 L_rpoll_x
    s_cbranch_vccz L_rpoll_x
    s_sleep 64
    s_branch L_rpoll
L_rpoll_x:
    v_xor_b32 v6, s44, v6
    v_xor_b32 v7, s61, v7
    v_or_b32 v6, v6, v7
    v_cmp_ne_u32 vcc, 0, v6
    s_cmp_eq_u64 vcc, 0
    s_cselect_b32 s44, 1, 0
    v_mov_b32 v6, s44
    ds_write_b32 v4, v6 offset:2824
    v_mov_b32 v5, 1
    s_mov_b64 exec, 1
    ds_add_u32 v4, v5 offset:3008
    s_mov_b64 exec, -1
    s_getpc_b64 s[44:45]
L_cpf:
    v_lshlrev_b32 v6, 7, v0
    v_min_u32 v6, L_end-L_cpf, v6
    global_load_dword v255, v6, s[44:45]
    s_lshr_b32 s44, s2, 3
    s_and_b32 s45, s44, 15
    s_lshr_b32 s44, s44, 4
    s_lshl_b32 s44, s44, 3
    s_and_b32 s46, s2, 7
    s_add_u32 s44, s44, s46
    v_mul_u32_u24 v8, 6144, v2
    v_lshl_add_u32 v8, v1, 4, v8
    s_mul_i32 s46, s44, 384
    s_mul_i32 s45, s45, 24576
    s_add_u32 s46, s46, s45
    s_add_u32 s46, s46, 0x10000
    v_and_b32 v10, 32, v0
    v_and_b32 v6, 1, v0
    v_lshl_add_u32 v10, v6, 4, v10
    v_bfe_u32 v6, v0, 1, 4
    v_add_u32 v10, v10, v6
    v_lshlrev_b32 v10, 4, v10
    v_lshrrev_b32 v11, 5, v0
    v_lshlrev_b32 v11, 3, v11
    s_mov_b32 s48, 0x00ff00ff
    s_mov_b32 s49, 0x00ff00ff
    v_mov_b32 v4, 0
    s_mov_b32 s60, 0
L_lw_13:
    ds_read_b32 v5, v4 offset:3008
    s_waitcnt lgkmcnt(0)
    v_cmp_le_u32 vcc, 6, v5
    s_add_u32 s60, s60, 1
    s_cmp_gt_u32 s60, 4000000
    s_cbranch_scc1 L_lw_13_x
    s_cbranch_vccnz L_lw_13_x
    s_branch L_lw_13
L_lw_13_x:
    ds_read_b64 v[12:13], v11 offset:2944
    ds_read_b64 v[14:15], v11 offset:2960
    ds_read_b64 v[16:17], v11 offset:2976
    ds_read_b64 v[18:19], v11 offset:2992
    ds_read_b128 v[20:23], v10 offset:3072
    ds_read_b128 v[24:27], v10 offset:4096
    ds_read_b128 v[28:31], v10 offset:5120
    ds_read_b128 v[32:35], v10 offset:6144
    s_waitcnt lgkmcnt(0)
    v_max3_f32 v36, v12, v14, v16
    v_max_f32 v36, v36, v18
    v_sub_f32 v12, v12, v36
    v_sub_f32 v14, v14, v36
    v_sub_f32 v16, v16, v36
    v_sub_f32 v18, v18, v36
    v_exp_f32 v12, v12
    v_exp_f32 v14, v14
    v_exp_f32 v16, v16
    v_exp_f32 v18, v18
    s_nop 0
    v_mul_f32 v40, v12, v20
    v_mul_f32 v41, v12, v21
    v_mul_f32 v42, v12, v22
    v_mul_f32 v43, v12, v23
    v_fmac_f32 v40, v14, v24
    v_fmac_f32 v41, v14, v25
    v_fmac_f32 v42, v14, v26
    v_fmac_f32 v43, v14, v27
    v_fmac_f32 v40, v16, v28
    v_fmac_f32 v41, v16, v29
    v_fmac_f32 v42, v16, v30
    v_fmac_f32 v43, v16, v31
    v_fmac_f32 v40, v18, v32
    v_fmac_f32 v41, v18, v33
    v_fmac_f32 v42, v18, v34
    v_fmac_f32 v43, v18, v35
    buffer_store_dwordx4 v[40:43], v8, s[28:31], s46 offen sc1
    v_mul_f32 v37, v12, v13
    v_fmac_f32 v37, v14, v15
    v_fmac_f32 v37, v16, v17
    v_fmac_f32 v37, v18, v19
    v_mov_b32 v38, v36
    v_mov_b32 v39, v37
    s_mov_b64 exec, s[48:49]
    buffer_store_dwordx4 v[36:39], v8, s[28:31], s46 offen offset:256 sc1
    s_mov_b64 exec, 1
    v_mov_b32 v5, 1
    ds_add_u32 v4, v5 offset:3008
    s_mov_b64 exec, -1
    s_setpc_b64 s[50:51]
L_w64:
L_wi:
    s_lshl_b32 s46, s3, 10
    s_add_u32 s46, s46, 26624
    s_mov_b32 m0, s46
    s_add_u32 s46, s46, 4096
    buffer_load_dwordx4 v204, s[36:39], s45 offen nt lds
    s_cbranch_vccz L_wn_14
    s_waitcnt vmcnt(5)
L_wn_14:
    s_mov_b32 m0, s46
    s_add_u32 s46, s46, 4096
    buffer_load_dwordx4 v205, s[36:39], s45 offen nt lds
    s_cbranch_vccz L_wn_15
    s_waitcnt vmcnt(5)
L_wn_15:
    s_mov_b32 m0, s46
    s_add_u32 s46, s46, 4096
    buffer_load_dwordx4 v206, s[36:39], s45 offen nt lds
    s_cbranch_vccz L_wn_16
    s_waitcnt vmcnt(5)
L_wn_16:
    s_mov_b32 m0, s46
    s_add_u32 s46, s46, 4096
    buffer_load_dwordx4 v207, s[36:39], s45 offen nt lds
    s_cbranch_vccz L_wn_17
    s_waitcnt vmcnt(5)
L_wn_17:
    s_mov_b32 m0, s46
    s_add_u32 s46, s46, 4096
    buffer_load_dwordx4 v208, s[36:39], s45 offen nt lds
    s_cbranch_vccz L_wn_18
    s_waitcnt vmcnt(5)
L_wn_18:
    s_mov_b32 m0, s46
    s_add_u32 s46, s46, 4096
    buffer_load_dwordx4 v209, s[36:39], s45 offen nt lds
    s_cbranch_vccz L_wn_19
    s_waitcnt vmcnt(5)
L_wn_19:
    s_mov_b32 m0, s46
    s_add_u32 s46, s46, 4096
    buffer_load_dwordx4 v210, s[36:39], s45 offen nt lds
    s_cbranch_vccz L_wn_20
    s_waitcnt vmcnt(5)
L_wn_20:
    s_mov_b32 m0, s46
    s_add_u32 s46, s46, 4096
    buffer_load_dwordx4 v211, s[36:39], s45 offen nt lds
    s_cbranch_vccz L_wn_21
    s_waitcnt vmcnt(5)
L_wn_21:
    s_mov_b32 m0, s46
    s_add_u32 s46, s46, 4096
    buffer_load_dwordx4 v212, s[36:39], s45 offen nt lds
    s_cbranch_vccz L_wn_22
    s_waitcnt vmcnt(5)
L_wn_22:
    s_mov_b32 m0, s46
    s_add_u32 s46, s46, 4096
    buffer_load_dwordx4 v213, s[36:39], s45 offen nt lds
    s_cbranch_vccz L_wn_23
    s_waitcnt vmcnt(5)
L_wn_23:
    s_mov_b32 m0, s46
    s_add_u32 s46, s46, 4096
    buffer_load_dwordx4 v214, s[36:39], s45 offen nt lds
    s_cbranch_vccz L_wn_24
    s_waitcnt vmcnt(5)
L_wn_24:
    s_mov_b32 m0, s46
    s_add_u32 s46, s46, 4096
    buffer_load_dwordx4 v215, s[36:39], s45 offen nt lds
    s_cbranch_vccz L_wn_25
    s_waitcnt vmcnt(5)
L_wn_25:
    s_mov_b32 m0, s46
    s_add_u32 s46, s46, 4096
    buffer_load_dwordx4 v216, s[36:39], s45 offen nt lds
    s_cbranch_vccz L_wn_26
    s_waitcnt vmcnt(5)
L_wn_26:
    s_mov_b32 m0, s46
    s_add_u32 s46, s46, 4096
    buffer_load_dwordx4 v217, s[36:39], s45 offen nt lds
    s_cbranch_vccz L_wn_27
    s_waitcnt vmcnt(5)
L_wn_27:
    s_mov_b32 m0, s46
    s_add_u32 s46, s46, 4096
    buffer_load_dwordx4 v218, s[36:39], s45 offen nt lds
    s_cbranch_vccz L_wn_28
    s_waitcnt vmcnt(5)
L_wn_28:
    s_mov_b32 m0, s46
    s_add_u32 s46, s46, 4096
    buffer_load_dwordx4 v219, s[36:39], s45 offen nt lds
    s_cbranch_vccz L_wn_29
    s_waitcnt vmcnt(5)
L_wn_29:
    s_mov_b32 m0, s46
    s_add_u32 s46, s46, 4096
    buffer_load_dwordx4 v220, s[36:39], s45 offen nt lds
    s_cbranch_vccz L_wn_30
    s_waitcnt vmcnt(5)
L_wn_30:
    s_mov_b32 m0, s46
    s_add_u32 s46, s46, 4096
    buffer_load_dwordx4 v221, s[36:39], s45 offen nt lds
    s_cbranch_vccz L_wn_31
    s_waitcnt vmcnt(5)
L_wn_31:
    s_setpc_b64 s[50:51]
L_wf:
    v_mov_b32 v8, 0
    v_mov_b32 v9, 1
    s_waitcnt vmcnt(0)
    s_mov_b64 exec, 1
    ds_add_u32 v8, v9 offset:3032
    s_mov_b64 exec, -1
    v_mov_b32 v10, 0
    s_mov_b32 s60, 0
L_lw_32:
    ds_read_b32 v11, v10 offset:3032
    s_waitcnt lgkmcnt(0)
    v_cmp_le_u32 vcc, s48, v11
    s_add_u32 s60, s60, 1
    s_cmp_gt_u32 s60, 4000000
    s_cbranch_scc1 L_lw_32_x
    s_cbranch_vccnz L_lw_32_x
    s_branch L_lw_32
L_lw_32_x:
L_wr:
    ds_read_b64_tr_b16 v[64:65], v222 offset:0
    ds_read_b64_tr_b16 v[66:67], v222 offset:18432
    ds_read_b64_tr_b16 v[68:69], v222 offset:36864
    ds_read_b64_tr_b16 v[70:71], v222 offset:55296
    ds_read_b64_tr_b16 v[72:73], v223 offset:0
    ds_read_b64_tr_b16 v[74:75], v223 offset:18432
    ds_read_b64_tr_b16 v[76:77], v223 offset:36864
    ds_read_b64_tr_b16 v[78:79], v223 offset:55296
    s_waitcnt lgkmcnt(4)
    ds_read_b64_tr_b16 v[80:81], v224 offset:0
    ds_read_b64_tr_b16 v[82:83], v224 offset:18432
    ds_read_b64_tr_b16 v[84:85], v224 offset:36864
    ds_read_b64_tr_b16 v[86:87], v224 offset:55296
    ds_read_b64_tr_b16 v[88:89], v225 offset:0
    ds_read_b64_tr_b16 v[90:91], v225 offset:18432
    ds_read_b64_tr_b16 v[92:93], v225 offset:36864
    ds_read_b64_tr_b16 v[94:95], v225 offset:55296
    s_waitcnt lgkmcnt(4)
    ds_read_b64_tr_b16 v[96:97], v222 offset:128
    ds_read_b64_tr_b16 v[98:99], v222 offset:18560
    ds_read_b64_tr_b16 v[100:101], v222 offset:36992
    ds_read_b64_tr_b16 v[102:103], v222 offset:55424
    ds_read_b64_tr_b16 v[104:105], v223 offset:128
    ds_read_b64_tr_b16 v[106:107], v223 offset:18560
    ds_read_b64_tr_b16 v[108:109], v223 offset:36992
    ds_read_b64_tr_b16 v[110:111], v223 offset:55424
    s_waitcnt lgkmcnt(4)
    ds_read_b64_tr_b16 v[112:113], v224 offset:128
    ds_read_b64_tr_b16 v[114:115], v224 offset:18560
    ds_read_b64_tr_b16 v[116:117], v224 offset:36992
    ds_read_b64_tr_b16 v[118:119], v224 offset:55424
    ds_read_b64_tr_b16 v[120:121], v225 offset:128
    ds_read_b64_tr_b16 v[122:123], v225 offset:18560
    ds_read_b64_tr_b16 v[124:125], v225 offset:36992
    ds_read_b64_tr_b16 v[126:127], v225 offset:55424
    s_waitcnt lgkmcnt(4)
    ds_read_b64_tr_b16 v[128:129], v226 offset:1024
    ds_read_b64_tr_b16 v[130:131], v226 offset:19456
    ds_read_b64_tr_b16 v[132:133], v226 offset:37888
    ds_read_b64_tr_b16 v[134:135], v226 offset:56320
    s_waitcnt lgkmcnt(0)
    s_setpc_b64 s[50:51]
L_role:
    s_cmp_eq_u32 s58, 2
    s_cselect_b32 s47, 8064, 0
    s_lshl_b32 s46, s3, 3
    v_lshrrev_b32 v5, 3, v0
    v_add_u32 v5, s46, v5
    v_mul_u32_u24 v5, 7282, v5
    v_lshlrev_b32 v8, 4, v0
    s_lshl_b32 s46, s3, 10
    v_add_u32 v8, s46, v8
    v_bfe_u32 v4, v5, 17, 2
    v_lshlrev_b32 v4, 5, v4
    v_xor_b32 v4, v4, v8
    v_lshrrev_b32 v6, 16, v5
    v_mad_u32_u24 v204, v6, s47, v4
    v_add_u32 v5, 233024, v5
    v_add_u32 v8, 4096, v8
    v_bfe_u32 v4, v5, 17, 2
    v_lshlrev_b32 v4, 5, v4
    v_xor_b32 v4, v4, v8
    v_lshrrev_b32 v6, 16, v5
    v_mad_u32_u24 v205, v6, s47, v4
    v_add_u32 v5, 233024, v5
    v_add_u32 v8, 4096, v8
    v_bfe_u32 v4, v5, 17, 2
    v_lshlrev_b32 v4, 5, v4
    v_xor_b32 v4, v4, v8
    v_lshrrev_b32 v6, 16, v5
    v_mad_u32_u24 v206, v6, s47, v4
    v_add_u32 v5, 233024, v5
    v_add_u32 v8, 4096, v8
    v_bfe_u32 v4, v5, 17, 2
    v_lshlrev_b32 v4, 5, v4
    v_xor_b32 v4, v4, v8
    v_lshrrev_b32 v6, 16, v5
    v_mad_u32_u24 v207, v6, s47, v4
    v_add_u32 v5, 233024, v5
    v_add_u32 v8, 4096, v8
    v_bfe_u32 v4, v5, 17, 2
    v_lshlrev_b32 v4, 5, v4
    v_xor_b32 v4, v4, v8
    v_lshrrev_b32 v6, 16, v5
    v_mad_u32_u24 v208, v6, s47, v4
    v_add_u32 v5, 233024, v5
    v_add_u32 v8, 4096, v8
    v_bfe_u32 v4, v5, 17, 2
    v_lshlrev_b32 v4, 5, v4
    v_xor_b32 v4, v4, v8
    v_lshrrev_b32 v6, 16, v5
    v_mad_u32_u24 v209, v6, s47, v4
    v_add_u32 v5, 233024, v5
    v_add_u32 v8, 4096, v8
    v_bfe_u32 v4, v5, 17, 2
    v_lshlrev_b32 v4, 5, v4
    v_xor_b32 v4, v4, v8
    v_lshrrev_b32 v6, 16, v5
    v_mad_u32_u24 v210, v6, s47, v4
    v_add_u32 v5, 233024, v5
    v_add_u32 v8, 4096, v8
    v_bfe_u32 v4, v5, 17, 2
    v_lshlrev_b32 v4, 5, v4
    v_xor_b32 v4, v4, v8
    v_lshrrev_b32 v6, 16, v5
    v_mad_u32_u24 v211, v6, s47, v4
    v_add_u32 v5, 233024, v5
    v_add_u32 v8, 4096, v8
    v_bfe_u32 v4, v5, 17, 2
    v_lshlrev_b32 v4, 5, v4
    v_xor_b32 v4, v4, v8
    v_lshrrev_b32 v6, 16, v5
    v_mad_u32_u24 v212, v6, s47, v4
    v_add_u32 v5, 233024, v5
    v_add_u32 v8, 4096, v8
    v_bfe_u32 v4, v5, 17, 2
    v_lshlrev_b32 v4, 5, v4
    v_xor_b32 v4, v4, v8
    v_lshrrev_b32 v6, 16, v5
    v_mad_u32_u24 v213, v6, s47, v4
    v_add_u32 v5, 233024, v5
    v_add_u32 v8, 4096, v8
    v_bfe_u32 v4, v5, 17, 2
    v_lshlrev_b32 v4, 5, v4
    v_xor_b32 v4, v4, v8
    v_lshrrev_b32 v6, 16, v5
    v_mad_u32_u24 v214, v6, s47, v4
    v_add_u32 v5, 233024, v5
    v_add_u32 v8, 4096, v8
    v_bfe_u32 v4, v5, 17, 2
    v_lshlrev_b32 v4, 5, v4
    v_xor_b32 v4, v4, v8
    v_lshrrev_b32 v6, 16, v5
    v_mad_u32_u24 v215, v6, s47, v4
    v_add_u32 v5, 233024, v5
    v_add_u32 v8, 4096, v8
    v_bfe_u32 v4, v5, 17, 2
    v_lshlrev_b32 v4, 5, v4
    v_xor_b32 v4, v4, v8
    v_lshrrev_b32 v6, 16, v5
    v_mad_u32_u24 v216, v6, s47, v4
    v_add_u32 v5, 233024, v5
    v_add_u32 v8, 4096, v8
    v_bfe_u32 v4, v5, 17, 2
    v_lshlrev_b32 v4, 5, v4
    v_xor_b32 v4, v4, v8
    v_lshrrev_b32 v6, 16, v5
    v_mad_u32_u24 v217, v6, s47, v4
    v_add_u32 v5, 233024, v5
    v_add_u32 v8, 4096, v8
    v_bfe_u32 v4, v5, 17, 2
    v_lshlrev_b32 v4, 5, v4
    v_xor_b32 v4, v4, v8
    v_lshrrev_b32 v6, 16, v5
    v_mad_u32_u24 v218, v6, s47, v4
    v_add_u32 v5, 233024, v5
    v_add_u32 v8, 4096, v8
    v_bfe_u32 v4, v5, 17, 2
    v_lshlrev_b32 v4, 5, v4
    v_xor_b32 v4, v4, v8
    v_lshrrev_b32 v6, 16, v5
    v_mad_u32_u24 v219, v6, s47, v4
    v_add_u32 v5, 233024, v5
    v_add_u32 v8, 4096, v8
    v_bfe_u32 v4, v5, 17, 2
    v_lshlrev_b32 v4, 5, v4
    v_xor_b32 v4, v4, v8
    v_lshrrev_b32 v6, 16, v5
    v_mad_u32_u24 v220, v6, s47, v4
    v_add_u32 v5, 233024, v5
    v_add_u32 v8, 4096, v8
    v_bfe_u32 v4, v5, 17, 2
    v_lshlrev_b32 v4, 5, v4
    v_xor_b32 v4, v4, v8
    v_lshrrev_b32 v6, 16, v5
    v_mad_u32_u24 v221, v6, s47, v4
    v_lshrrev_b32 v10, 2, v0
    v_mul_u32_u24 v10, 1152, v10
    v_and_b32 v11, 3, v0
    v_lshl_add_u32 v10, v11, 3, v10
    v_bfe_u32 v11, v0, 3, 2
    v_add_u32 v10, 26624, v10
    v_xor_b32 v226, s3, v11
    v_lshl_add_u32 v226, v226, 5, v10
    s_lshl_b32 s46, s3, 8
    v_add_u32 v10, s46, v10
    v_xor_b32 v222, 0, v11
    v_lshl_add_u32 v222, v222, 5, v10
    v_xor_b32 v223, 1, v11
    v_lshl_add_u32 v223, v223, 5, v10
    v_xor_b32 v224, 2, v11
    v_lshl_add_u32 v224, v224, 5, v10
    v_xor_b32 v225, 3, v11
    v_lshl_add_u32 v225, v225, 5, v10
    v_mov_b32 v8, 0
    v_mov_b32 v9, 0
    v_lshlrev_b32 v12, 3, v0
    ds_write_b64 v12, v[8:9] offset:7168
    v_and_b32 v12, 1, v0
    v_lshlrev_b32 v48, 7, v12
    v_lshl_add_u32 v48, v2, 4, v48
    v_add_u32 v48, 7680, v48
    v_lshrrev_b32 v14, 1, v1
    v_mov_b32 v15, 7232
    v_cmp_eq_u32 vcc, 0, v14
    s_nop 1
    v_cndmask_b32 v56, v15, v48, vcc
    v_cmp_eq_u32 vcc, 1, v14
    s_nop 1
    v_cndmask_b32 v57, v15, v48, vcc
    v_cmp_eq_u32 vcc, 2, v14
    s_nop 1
    v_cndmask_b32 v58, v15, v48, vcc
    v_cmp_eq_u32 vcc, 3, v14
    s_nop 1
    v_cndmask_b32 v59, v15, v48, vcc
    v_cmp_eq_u32 vcc, 4, v14
    s_nop 1
    v_cndmask_b32 v60, v15, v48, vcc
    v_cmp_eq_u32 vcc, 5, v14
    s_nop 1
    v_cndmask_b32 v61, v15, v48, vcc
    v_cmp_eq_u32 vcc, 6, v14
    s_nop 1
    v_cndmask_b32 v62, v15, v48, vcc
    v_cmp_eq_u32 vcc, 7, v14
    s_nop 1
    v_cndmask_b32 v63, v15, v48, vcc
    v_bfe_u32 v52, v0, 3, 1
    v_lshl_add_u32 v52, v52, 2, v2
    v_mul_u32_u24 v52, 9216, v52
    v_and_b32 v14, 7, v0
    v_lshl_add_u32 v52, v14, 4, v52
    v_lshlrev_b32 v49, 5, v2
    v_lshl_add_u32 v49, v12, 4, v49
    v_lshlrev_b32 v50, 4, v0
    v_mul_u32_u24 v51, 384, v2
    v_lshl_add_u32 v53, v1, 4, v51
    s_mov_b32 s56, 0x00030003
    s_mov_b32 s57, 0x00030003
    s_mov_b32 s96, 0
    s_waitcnt lgkmcnt(0)
    s_cmp_eq_u32 s58, 2
    s_cbranch_scc1 L_a
    s_mul_i32 s98, s97, 57
    s_lshr_b32 s98, s98, 9
    s_mul_i32 s99, s98, 9
    s_sub_u32 s99, s97, s99
    s_lshr_b32 s46, s98, 2
    s_mul_i32 s46, s46, 9
    s_add_u32 s46, s46, s99
    s_mul_i32 s101, s46, 36864
    s_and_b32 s46, s98, 3
    s_mul_i32 s46, s46, 2304
    s_add_u32 s101, s101, s46
    s_add_u32 s101, s101, 0x200000
    s_sub_u32 s63, s3, 1
    s_cmp_eq_u32 s58, 3
    s_cbranch_scc1 L_ob_s
    s_mov_b32 s36, s12
    s_mov_b32 s37, s13
    s_mov_b32 s38, 0x480000
    s_mov_b32 s39, 0x20000
    s_mul_i32 s45, s59, 73728
    s_mov_b32 s48, 4
    s_cmp_eq_u32 s3, 0
    s_cselect_b64 vcc, 0, 1
    s_call_b64 s[50:51], L_wi
    s_call_b64 s[50:51], L_wf
    s_lshl_b32 s46, s3, 4
    v_add_u32 v4, s46, v1
    v_mul_u32_u24 v4, 1152, v4
    v_lshl_add_u32 v4, v2, 4, v4
    v_add_u32 v4, 26624, v4
    v_mov_b32 v28, 0x3f803f80
    v_mov_b32 v29, v28
    v_mov_b32 v30, v28
    v_mov_b32 v31, v28
    ds_read_b128 v[140:143], v4 offset:0
    ds_read_b128 v[144:147], v4 offset:64
    ds_read_b128 v[148:151], v4 offset:128
    ds_read_b128 v[152:155], v4 offset:192
    ds_read_b128 v[156:159], v4 offset:256
    ds_read_b128 v[160:163], v4 offset:320
    ds_read_b128 v[164:167], v4 offset:384
    ds_read_b128 v[168:171], v4 offset:448
    ds_read_b128 v[172:175], v4 offset:512
    s_waitcnt lgkmcnt(0)
    v_mfma_f32_16x16x32_bf16 v[12:15], v[140:143], v[28:31], 0
    v_mfma_f32_16x16x32_bf16 v[12:15], v[144:147], v[28:31], v[12:15]
    v_mfma_f32_16x16x32_bf16 v[12:15], v[148:151], v[28:31], v[12:15]
    v_mfma_f32_16x16x32_bf16 v[12:15], v[152:155], v[28:31], v[12:15]
    v_mfma_f32_16x16x32_bf16 v[12:15], v[156:159], v[28:31], v[12:15]
    v_mfma_f32_16x16x32_bf16 v[12:15], v[160:163], v[28:31], v[12:15]
    v_mfma_f32_16x16x32_bf16 v[12:15], v[164:167], v[28:31], v[12:15]
    v_mfma_f32_16x16x32_bf16 v[12:15], v[168:171], v[28:31], v[12:15]
    v_mfma_f32_16x16x32_bf16 v[12:15], v[172:175], v[28:31], v[12:15]
    ds_read_b128 v[140:143], v4 offset:576
    ds_read_b128 v[144:147], v4 offset:640
    ds_read_b128 v[148:151], v4 offset:704
    ds_read_b128 v[152:155], v4 offset:768
    ds_read_b128 v[156:159], v4 offset:832
    ds_read_b128 v[160:163], v4 offset:896
    ds_read_b128 v[164:167], v4 offset:960
    ds_read_b128 v[168:171], v4 offset:1024
    ds_read_b128 v[172:175], v4 offset:1088
    s_waitcnt lgkmcnt(0)
    v_mfma_f32_16x16x32_bf16 v[12:15], v[140:143], v[28:31], v[12:15]
    v_mfma_f32_16x16x32_bf16 v[12:15], v[144:147], v[28:31], v[12:15]
    v_mfma_f32_16x16x32_bf16 v[12:15], v[148:151], v[28:31], v[12:15]
    v_mfma_f32_16x16x32_bf16 v[12:15], v[152:155], v[28:31], v[12:15]
    v_mfma_f32_16x16x32_bf16 v[12:15], v[156:159], v[28:31], v[12:15]
    v_mfma_f32_16x16x32_bf16 v[12:15], v[160:163], v[28:31], v[12:15]
    v_mfma_f32_16x16x32_bf16 v[12:15], v[164:167], v[28:31], v[12:15]
    v_mfma_f32_16x16x32_bf16 v[12:15], v[168:171], v[28:31], v[12:15]
    v_mfma_f32_16x16x32_bf16 v[12:15], v[172:175], v[28:31], v[12:15]
    s_lshr_b32 s46, s3, 1
    s_lshl_b32 s46, s46, 6
    s_and_b32 s47, s3, 1
    s_lshl_b32 s47, s47, 3
    s_add_u32 s46, s46, s47
    v_lshlrev_b32 v4, 4, v2
    v_add_u32 v4, s46, v4
    s_mov_b32 s40, 0xffff0000
    s_nop 3
    v_mul_f32 v12, 0xbae38e39, v12
    v_mul_f32 v13, 0xbae38e39, v13
    v_mul_f32 v14, 0xbae38e39, v14
    v_mul_f32 v15, 0xbae38e39, v15
    v_cvt_pk_bf16_f32 v16, v12, v13
    v_cvt_pk_bf16_f32 v17, v14, v15
    v_lshlrev_b32 v20, 16, v16
    v_and_b32 v21, s40, v16
    v_lshlrev_b32 v22, 16, v17
    v_and_b32 v23, s40, v17
    v_sub_f32 v12, v12, v20
    v_sub_f32 v13, v13, v21
    v_sub_f32 v14, v14, v22
    v_sub_f32 v15, v15, v23
    v_cvt_pk_bf16_f32 v18, v12, v13
    v_cvt_pk_bf16_f32 v19, v14, v15
    ds_write_b64 v4, v[16:17] offset:7936
    ds_write_b64 v4, v[18:19] offset:8064
    s_mov_b64 exec, 1
    ds_add_u32 v8, v9 offset:3036
    s_mov_b64 exec, -1
    v_mov_b32 v10, 0
    s_mov_b32 s60, 0
L_lw_33:
    ds_read_b32 v11, v10 offset:3036
    s_waitcnt lgkmcnt(0)
    v_cmp_le_u32 vcc, 4, v11
    s_add_u32 s60, s60, 1
    s_cmp_gt_u32 s60, 4000000
    s_cbranch_scc1 L_lw_33_x
    s_cbranch_vccnz L_lw_33_x
    s_sleep 1
    s_branch L_lw_33
L_lw_33_x:
    v_lshlrev_b32 v4, 4, v2
    ds_read_b128 v[228:231], v4 offset:7936
    ds_read_b128 v[232:235], v4 offset:8000
    ds_read_b128 v[236:239], v4 offset:8064
    ds_read_b128 v[240:243], v4 offset:8128
    v_lshrrev_b32 v4, 3, v1
    v_lshlrev_b32 v55, 6, v4
    v_and_b32 v4, 3, v0
    v_lshl_add_u32 v55, v4, 4, v55
    v_bfe_u32 v5, v0, 2, 1
    v_lshl_add_u32 v55, v5, 3, v55
    v_lshl_add_u32 v55, v2, 1, v55
    s_lshl_b32 s46, s63, 7
    v_add_u32 v55, s46, v55
    s_lshl_b32 s46, s59, 7
    s_add_u32 s46, s46, 0x70000
    s_mul_i32 s54, s3, 73728
    s_add_u32 s54, s54, s46
    s_mul_i32 s55, s3, 9216
    s_add_u32 s55, s55, s46
    s_add_u32 s55, s55, 294912
    s_waitcnt lgkmcnt(0)
L_ob_s:
    s_mov_b32 s36, s20
    s_mov_b32 s37, s21
    s_mov_b32 s38, 0x510000
    s_mov_b32 s39, 0x20000
    v_bfe_u32 v16, v0, 1, 2
    v_mov_b32 v17, s3
    s_cmp_eq_u32 s99, 8
    s_cselect_b64 vcc, -1, 0
    v_and_b32 v24, 1, v0
    v_cndmask_b32 v18, v16, v17, vcc
    v_cndmask_b32 v19, v17, v16, vcc
    v_lshlrev_b32 v54, 7, v24
    v_lshl_add_u32 v54, v19, 4, v54
    v_lshl_add_u32 v54, v2, 1, v54
    v_lshrrev_b32 v16, 1, v18
    v_lshl_add_u32 v54, v16, 6, v54
    v_and_b32 v16, 1, v18
    v_lshl_add_u32 v54, v16, 3, v54
    s_mul_i32 s45, s97, 73728
    s_cmp_lg_u32 s3, 0
    s_cbranch_scc1 L_ob_1
    s_call_b64 s[50:51], L_finish
    s_branch L_ob_p
L_ob_1:
    s_cmp_eq_u32 s3, 3
    s_cbranch_scc1 L_ob_x
    s_cmp_lg_u32 s58, 1
    s_cbranch_scc1 L_ob_g
    s_mov_b64 vcc, 1
    s_call_b64 s[50:51], L_wi
    s_branch L_ob_g
L_ob_x:
    s_mov_b32 s52, s101
    s_cmp_eq_u32 s58, 0
    s_cselect_b32 s53, 0, 9216
    s_cmp_eq_u32 s58, 1
    s_cselect_b32 s49, 1, 0
    s_call_b64 s[50:51], L_box
L_ob_g:
    v_mov_b32 v5, 0
    s_mov_b32 s60, 0
L_lw_34:
    ds_read_b32 v6, v5 offset:3008
    s_waitcnt lgkmcnt(0)
    v_cmp_le_u32 vcc, 7, v6
    s_add_u32 s60, s60, 1
    s_cmp_gt_u32 s60, 4000000
    s_cbranch_scc1 L_lw_34_x
    s_cbranch_vccnz L_lw_34_x
    s_sleep 1
    s_branch L_lw_34
L_lw_34_x:
L_ob_p:
    s_mul_i32 s45, s97, 73728
    s_mov_b32 s48, 4
    s_cmp_eq_u32 s58, 3
    s_cbranch_scc1 L_ob_li
    s_mov_b32 s48, 8
    s_cmp_ge_u32 s63, 2
    s_cbranch_scc1 L_ob_2
    s_mul_i32 s52, s59, 6144
    s_mul_i32 s53, s63, 3072
    s_add_u32 s52, s52, s53
    s_add_u32 s52, s52, 0x10000
    s_mov_b32 s60, 0
L_op_poll:
    buffer_load_dwordx2 v[12:13], v51, s[28:31], s52 offen offset:256 sc1
    buffer_load_dwordx2 v[14:15], v51, s[28:31], s52 offen offset:1792 sc1
    buffer_load_dwordx4 v[16:19], v53, s[28:31], s52 offen sc1
    buffer_load_dwordx4 v[20:23], v53, s[28:31], s52 offen offset:1536 sc1
    s_waitcnt vmcnt(0)
    v_max3_u32 v24, v12, v13, v14
    v_max3_u32 v24, v24, v15, v16
    v_max3_u32 v24, v24, v17, v18
    v_max3_u32 v24, v24, v19, v20
    v_max3_u32 v24, v24, v21, v22
    v_max_u32 v24, v24, v23
    v_cmp_eq_u32 vcc, -1, v24
    s_add_u32 s60, s60, 1
    s_cmp_gt_u32 s60, 200000
    s_cbranch_scc1 L_op_poll_x
    s_cbranch_vccnz L_op_poll
L_op_poll_x:
    v_max_f32 v24, v12, v14
    v_mov_b32 v25, v24
    s_nop 1
    v_permlane16_swap_b32 v24, v25
    v_max_f32 v24, v24, v25
    v_mov_b32 v25, v24
    s_nop 1
    v_permlane32_swap_b32 v24, v25
    v_max_f32 v24, v24, v25
    v_sub_f32 v12, v12, v24
    v_sub_f32 v14, v14, v24
    v_exp_f32 v12, v12
    v_exp_f32 v14, v14
    s_nop 0
    v_mul_f32 v13, v12, v13
    v_fmac_f32 v13, v14, v15
    v_mul_f32 v16, v12, v16
    v_mul_f32 v17, v12, v17
    v_mul_f32 v18, v12, v18
    v_mul_f32 v19, v12, v19
    v_mov_b32 v25, v13
    v_fmac_f32 v16, v14, v20
    v_fmac_f32 v17, v14, v21
    v_fmac_f32 v18, v14, v22
    v_fmac_f32 v19, v14, v23
    v_permlane16_swap_b32 v13, v25
    v_add_f32 v13, v13, v25
    v_permlane32_swap_b32 v16, v18
    v_mov_b32 v25, v13
    v_permlane32_swap_b32 v17, v19
    v_add_f32 v16, v16, v18
    v_add_f32 v17, v17, v19
    v_permlane32_swap_b32 v13, v25
    v_add_f32 v13, v13, v25
    v_permlane16_swap_b32 v16, v17
    v_rcp_f32 v13, v13
    v_add_f32 v16, v16, v17
    v_mul_f32 v16, v16, v13
    v_cvt_pk_bf16_f32 v16, v16, v16
    ds_write_b16 v55, v16 offset:7680
    s_waitcnt lgkmcnt(0)
L_ob_2:
L_mmo:
    s_barrier
    ds_read_b128 v[28:31], v48
    ds_read_b128 v[32:35], v48 offset:64
    ds_read_b128 v[140:143], v56 offset:0
    ds_read_b128 v[144:147], v56 offset:64
    ds_read_b128 v[148:151], v57 offset:0
    ds_read_b128 v[152:155], v57 offset:64
    ds_read_b128 v[156:159], v58 offset:0
    ds_read_b128 v[160:163], v58 offset:64
    s_waitcnt lgkmcnt(7)
    v_mfma_f32_16x16x32_bf16 v[20:23], v[228:231], v[28:31], 0
    ds_read_b128 v[164:167], v59 offset:0
    v_mfma_f32_16x16x32_bf16 v[20:23], v[236:239], v[28:31], v[20:23]
    s_waitcnt lgkmcnt(7)
    v_mfma_f32_16x16x32_bf16 v[20:23], v[232:235], v[32:35], v[20:23]
    ds_read_b128 v[168:171], v59 offset:64
    v_mfma_f32_16x16x32_bf16 v[20:23], v[240:243], v[32:35], v[20:23]
    ds_read_b128 v[172:175], v60 offset:0
    ds_read_b128 v[176:179], v60 offset:64
    s_nop 3
    s_waitcnt lgkmcnt(9)
    v_mfma_f32_16x16x32_bf16 v[12:15], v[64:67], v[140:143], v[20:23]
    ds_read_b128 v[180:183], v61 offset:0
    v_mfma_f32_16x16x32_bf16 v[16:19], v[128:131], v[140:143], v[20:23]
    ds_read_b128 v[184:187], v61 offset:64
    s_waitcnt lgkmcnt(10)
    v_mfma_f32_16x16x32_bf16 v[12:15], v[68:71], v[144:147], v[12:15]
    ds_read_b128 v[188:191], v62 offset:0
    v_mfma_f32_16x16x32_bf16 v[16:19], v[132:135], v[144:147], v[16:19]
    ds_read_b128 v[192:195], v62 offset:64
    s_waitcnt lgkmcnt(11)
    v_mfma_f32_16x16x32_bf16 v[12:15], v[72:75], v[148:151], v[12:15]
    ds_read_b128 v[196:199], v63 offset:0
    s_waitcnt lgkmcnt(11)
    v_mfma_f32_16x16x32_bf16 v[12:15], v[76:79], v[152:155], v[12:15]
    ds_read_b128 v[200:203], v63 offset:64
    s_waitcnt lgkmcnt(11)
    v_mfma_f32_16x16x32_bf16 v[12:15], v[80:83], v[156:159], v[12:15]
    s_waitcnt lgkmcnt(10)
    v_mfma_f32_16x16x32_bf16 v[12:15], v[84:87], v[160:163], v[12:15]
    s_waitcnt lgkmcnt(9)
    v_mfma_f32_16x16x32_bf16 v[12:15], v[88:91], v[164:167], v[12:15]
    s_waitcnt lgkmcnt(8)
    v_mfma_f32_16x16x32_bf16 v[12:15], v[92:95], v[168:171], v[12:15]
    s_waitcnt lgkmcnt(7)
    v_mfma_f32_16x16x32_bf16 v[12:15], v[96:99], v[172:175], v[12:15]
    s_waitcnt lgkmcnt(6)
    v_mfma_f32_16x16x32_bf16 v[12:15], v[100:103], v[176:179], v[12:15]
    s_waitcnt lgkmcnt(5)
    v_mfma_f32_16x16x32_bf16 v[12:15], v[104:107], v[180:183], v[12:15]
    s_waitcnt lgkmcnt(4)
    v_mfma_f32_16x16x32_bf16 v[12:15], v[108:111], v[184:187], v[12:15]
    s_waitcnt lgkmcnt(3)
    v_mfma_f32_16x16x32_bf16 v[12:15], v[112:115], v[188:191], v[12:15]
    s_waitcnt lgkmcnt(2)
    v_mfma_f32_16x16x32_bf16 v[12:15], v[116:119], v[192:195], v[12:15]
    s_waitcnt lgkmcnt(1)
    v_mfma_f32_16x16x32_bf16 v[12:15], v[120:123], v[196:199], v[12:15]
    s_waitcnt lgkmcnt(0)
    v_mfma_f32_16x16x32_bf16 v[12:15], v[124:127], v[200:203], v[12:15]
    s_mov_b64 exec, s[56:57]
    buffer_store_dwordx4 v[16:19], v49, s[28:31], s55 offen sc1
    s_mov_b64 exec, -1
    s_nop 4
    buffer_store_dwordx4 v[12:15], v52, s[28:31], s54 offen sc1
    s_lshl_b32 s46, s59, 5
    s_add_u32 s46, s46, 0xc1000
    s_cmp_eq_u32 s3, 1
    s_cselect_b64 exec, 3, 0
    buffer_store_dwordx4 v[20:23], v50, s[28:31], s46 offen sc1
    s_mov_b64 exec, -1
    s_cmp_eq_u32 s58, 0
    s_cbranch_scc1 L_ob_end
    s_cmp_lt_u32 s63, 2
    s_cbranch_scc1 L_ob_3
L_ob_li:
    s_mov_b64 vcc, 0
    s_call_b64 s[50:51], L_wi
L_ob_3:
    s_call_b64 s[50:51], L_wf
    s_lshl_b32 s46, s97, 7
    s_add_u32 s46, s46, 0xd0000
    s_mul_i32 s54, s3, 73728
    s_add_u32 s54, s54, s46
    s_mul_i32 s55, s3, 9216
    s_add_u32 s55, s55, s46
    s_add_u32 s55, s55, 294912
    s_mul_i32 s52, s3, 9216
    s_add_u32 s52, s52, s101
    s_mul_i32 s41, s98, 1152
    s_add_u32 s41, s41, 0xc2000
    s_mov_b32 s42, 0x00ff00ff
    s_mov_b32 s43, 0x00ff00ff
    s_mov_b32 s46, -1
    s_mov_b32 s47, 15
    s_mov_b32 s48, 0x3d372713
    s_mov_b32 s49, 0xc0135761
    s_mov_b32 s44, 0xaaaaaaaa
    s_mov_b32 s45, 0xaaaaaaaa
    v_lshrrev_b32 v4, 2, v0
    v_lshlrev_b32 v4, 7, v4
    v_and_b32 v5, 3, v0
    v_lshl_add_u32 v4, v5, 3, v4
    v_mov_b32 v12, 0
    v_mov_b32 v13, 0
    v_mov_b32 v148, 0
    v_mov_b32 v149, 0
    v_mov_b32 v150, 0
    v_mov_b32 v151, 0
    s_mov_b64 exec, s[46:47]
    s_mov_b32 s60, 0
L_s_poll:
    buffer_load_dwordx2 v[12:13], v4, s[28:31], s41 offen sc1
    s_waitcnt vmcnt(0)
    v_max_u32 v14, v12, v13
    v_cmp_eq_u32 vcc, -1, v14
    s_add_u32 s60, s60, 1
    s_cmp_gt_u32 s60, 200000
    s_cbranch_scc1 L_s_poll_x
    s_cbranch_vccnz L_s_poll
L_s_poll_x:
    s_mov_b64 exec, -1
    buffer_load_dwordx4 v[140:143], v50, s[28:31], s52 offen sc1
    buffer_load_dwordx4 v[144:147], v50, s[28:31], s52 offen offset:1024 sc1
    s_mov_b64 exec, 0xffff
    buffer_load_dwordx4 v[148:151], v50, s[28:31], s52 offen offset:2048 sc1
    s_mov_b64 exec, -1
    v_permlane32_swap_b32 v12, v13
    v_add_f32 v12, v12, v13
    v_mov_b32 v13, v12
    s_nop 1
    v_permlane16_swap_b32 v12, v13
    v_add_f32 v12, v12, v13
    s_nop 1
    v_add_f32_dpp v12, v12, v12 row_ror:8 row_mask:0xf bank_mask:0xf
    s_nop 1
    v_add_f32_dpp v12, v12, v12 row_ror:4 row_mask:0xf bank_mask:0xf
    s_nop 1
    v_add_f32_dpp v12, v12, v12 row_ror:2 row_mask:0xf bank_mask:0xf
    s_nop 1
    v_add_f32_dpp v12, v12, v12 row_ror:1 row_mask:0xf bank_mask:0xf
    v_mov_b32 v14, 0x3727c5ac
    v_fmac_f32 v14, 0x3ae38e39, v12
    v_rsq_f32 v14, v14
    s_nop 0
    v_mov_b32 v15, v14
    s_nop 1
    v_permlane32_swap_b32 v14, v15
    v_cndmask_b32 v14, v14, v15, s[44:45]
    s_mov_b32 s60, 0
    s_branch L_b_c
L_b_poll:
    buffer_load_dwordx4 v[140:143], v50, s[28:31], s52 offen sc1
    buffer_load_dwordx4 v[144:147], v50, s[28:31], s52 offen offset:1024 sc1
    s_mov_b64 exec, 0xffff
    buffer_load_dwordx4 v[148:151], v50, s[28:31], s52 offen offset:2048 sc1
    s_mov_b64 exec, -1
L_b_c:
    s_waitcnt vmcnt(1)
    v_pk_add_f32 v[140:141], v[140:141], v[144:145]
    v_pk_add_f32 v[142:143], v[142:143], v[146:147]
    s_waitcnt vmcnt(0)
    v_pk_add_f32 v[140:141], v[140:141], v[148:149]
    v_pk_add_f32 v[142:143], v[142:143], v[150:151]
    s_add_u32 s60, s60, 1
    s_cmp_gt_u32 s60, 200000
    v_permlane32_swap_b32 v140, v142
    v_permlane32_swap_b32 v141, v143
    v_add_f32 v140, v140, v142
    v_add_f32 v141, v141, v143
    s_nop 1
    v_permlane16_swap_b32 v140, v141
    v_add_f32 v12, v140, v141
    v_cmp_u_f32 vcc, v12, v12
    v_mul_f32 v12, v12, v14
    s_cbranch_scc1 L_b_poll_x
    s_cbranch_vccnz L_b_poll
L_b_poll_x:
    v_mul_f32 v13, v12, v12
    v_fma_f32 v13, v13, s48, 1.0
    v_mul_f32 v15, s49, v12
    v_mul_f32 v13, v13, v15
    v_exp_f32 v13, v13
    v_mul_f32_dpp v12, v12, v12 row_ror:8 row_mask:0xf bank_mask:0xf
    v_add_f32 v13, 1.0, v13
    v_rcp_f32 v13, v13
    s_mov_b64 exec, s[42:43]
    v_mul_f32 v12, v12, v13
    v_cvt_pk_bf16_f32 v12, v12, v12
    ds_write_b16 v54, v12 offset:7680
    s_mov_b64 exec, -1
    s_waitcnt lgkmcnt(0)
    s_barrier
    ds_read_b128 v[140:143], v56 offset:0
    ds_read_b128 v[144:147], v56 offset:64
    ds_read_b128 v[148:151], v57 offset:0
    ds_read_b128 v[152:155], v57 offset:64
    ds_read_b128 v[156:159], v58 offset:0
    ds_read_b128 v[160:163], v58 offset:64
    s_waitcnt lgkmcnt(5)
    v_mfma_f32_16x16x32_bf16 v[12:15], v[64:67], v[140:143], 0
    ds_read_b128 v[164:167], v59 offset:0
    v_mfma_f32_16x16x32_bf16 v[16:19], v[128:131], v[140:143], 0
    ds_read_b128 v[168:171], v59 offset:64
    s_waitcnt lgkmcnt(6)
    v_mfma_f32_16x16x32_bf16 v[12:15], v[68:71], v[144:147], v[12:15]
    ds_read_b128 v[172:175], v60 offset:0
    v_mfma_f32_16x16x32_bf16 v[16:19], v[132:135], v[144:147], v[16:19]
    ds_read_b128 v[176:179], v60 offset:64
    s_waitcnt lgkmcnt(7)
    v_mfma_f32_16x16x32_bf16 v[12:15], v[72:75], v[148:151], v[12:15]
    ds_read_b128 v[180:183], v61 offset:0
    s_waitcnt lgkmcnt(7)
    v_mfma_f32_16x16x32_bf16 v[12:15], v[76:79], v[152:155], v[12:15]
    ds_read_b128 v[184:187], v61 offset:64
    s_waitcnt lgkmcnt(7)
    v_mfma_f32_16x16x32_bf16 v[12:15], v[80:83], v[156:159], v[12:15]
    ds_read_b128 v[188:191], v62 offset:0
    s_waitcnt lgkmcnt(7)
    v_mfma_f32_16x16x32_bf16 v[12:15], v[84:87], v[160:163], v[12:15]
    ds_read_b128 v[192:195], v62 offset:64
    s_waitcnt lgkmcnt(7)
    v_mfma_f32_16x16x32_bf16 v[12:15], v[88:91], v[164:167], v[12:15]
    ds_read_b128 v[196:199], v63 offset:0
    s_waitcnt lgkmcnt(7)
    v_mfma_f32_16x16x32_bf16 v[12:15], v[92:95], v[168:171], v[12:15]
    ds_read_b128 v[200:203], v63 offset:64
    s_waitcnt lgkmcnt(7)
    v_mfma_f32_16x16x32_bf16 v[12:15], v[96:99], v[172:175], v[12:15]
    s_waitcnt lgkmcnt(6)
    v_mfma_f32_16x16x32_bf16 v[12:15], v[100:103], v[176:179], v[12:15]
    s_waitcnt lgkmcnt(5)
    v_mfma_f32_16x16x32_bf16 v[12:15], v[104:107], v[180:183], v[12:15]
    s_waitcnt lgkmcnt(4)
    v_mfma_f32_16x16x32_bf16 v[12:15], v[108:111], v[184:187], v[12:15]
    s_waitcnt lgkmcnt(3)
    v_mfma_f32_16x16x32_bf16 v[12:15], v[112:115], v[188:191], v[12:15]
    s_waitcnt lgkmcnt(2)
    v_mfma_f32_16x16x32_bf16 v[12:15], v[116:119], v[192:195], v[12:15]
    s_waitcnt lgkmcnt(1)
    v_mfma_f32_16x16x32_bf16 v[12:15], v[120:123], v[196:199], v[12:15]
    s_waitcnt lgkmcnt(0)
    v_mfma_f32_16x16x32_bf16 v[12:15], v[124:127], v[200:203], v[12:15]
    s_mov_b64 exec, s[56:57]
    buffer_store_dwordx4 v[16:19], v49, s[28:31], s55 offen sc1
    s_mov_b64 exec, -1
    s_nop 4
    buffer_store_dwordx4 v[12:15], v52, s[28:31], s54 offen sc1
L_ob_end:
    s_endpgm
L_a:
    s_lshl_b32 s59, s62, 2
    s_add_u32 s59, s59, s3
    v_bfe_u32 v16, v0, 1, 2
    v_mov_b32 v17, s3
    s_cmp_eq_u32 s62, 8
    s_cselect_b64 vcc, -1, 0
    v_and_b32 v24, 1, v0
    v_cndmask_b32 v18, v16, v17, vcc
    v_cndmask_b32 v19, v17, v16, vcc
    v_lshlrev_b32 v54, 7, v24
    v_lshl_add_u32 v54, v19, 4, v54
    v_lshl_add_u32 v54, v2, 1, v54
    v_lshrrev_b32 v16, 1, v18
    v_lshl_add_u32 v54, v16, 6, v54
    v_and_b32 v16, 1, v18
    v_lshl_add_u32 v54, v16, 3, v54
    s_mov_b32 s36, s4
    s_mov_b32 s37, s5
    s_mov_b32 s38, 0x900
    s_mov_b32 s39, 0x20000
    v_mul_u32_u24 v51, 1152, v24
    v_lshl_add_u32 v51, v18, 5, v51
    v_lshl_add_u32 v51, v19, 3, v51
    v_lshl_add_u32 v51, v2, 1, v51
    s_lshl_b32 s45, s62, 7
    v_add_u32 v51, s45, v51
    buffer_load_ushort v53, v51, s[36:39], 0 offen
    v_lshlrev_b32 v55, 2, v24
    s_lshr_b32 s98, s63, 1
    s_lshr_b32 s46, s98, 2
    s_mul_i32 s46, s46, 331776
    s_and_b32 s47, s98, 3
    s_mul_i32 s47, s47, 9
    s_add_u32 s47, s47, s62
    s_lshl_b32 s47, s47, 1
    s_and_b32 s99, s63, 1
    s_add_u32 s47, s47, s99
    s_lshl_b32 s47, s47, 7
    s_add_u32 s46, s46, s47
    s_add_u32 s46, s46, 0x200000
    s_mul_i32 s54, s3, 73728
    s_add_u32 s54, s54, s46
    s_mul_i32 s55, s3, 9216
    s_add_u32 s55, s55, s46
    s_add_u32 s55, s55, 294912
    s_waitcnt vmcnt(0)
    v_lshlrev_b32 v53, 16, v53
    s_cmp_eq_u32 s99, 0
    s_cselect_b32 s36, s16, s18
    s_cselect_b32 s37, s17, s19
    s_mov_b32 s38, 5308416
    s_mov_b32 s39, 0x20000
    s_cmp_lg_u32 s3, 0
    s_cbranch_scc1 L_a_1
    s_call_b64 s[50:51], L_finish
    s_branch L_a_2
L_a_1:
    s_cmp_lg_u32 s3, 3
    s_cbranch_scc1 L_a_w
    s_lshl_b32 s52, s62, 2
    s_add_u32 s52, s52, s63
    s_mul_i32 s52, s52, 9216
    s_add_u32 s52, s52, 0xd0000
    s_cmp_lt_u32 s63, 4
    s_cselect_b32 s53, 2304, 0
    s_mov_b32 s49, 0
    s_call_b64 s[50:51], L_box
L_a_w:
    v_mov_b32 v12, 0
    s_mov_b32 s60, 0
L_lw_35:
    ds_read_b32 v13, v12 offset:3008
    s_waitcnt lgkmcnt(0)
    v_cmp_le_u32 vcc, 7, v13
    s_add_u32 s60, s60, 1
    s_cmp_gt_u32 s60, 4000000
    s_cbranch_scc1 L_lw_35_x
    s_cbranch_vccnz L_lw_35_x
    s_sleep 1
    s_branch L_lw_35
L_lw_35_x:
L_a_2:
    s_mul_i32 s45, s62, 589824
    s_mul_i32 s46, s98, 1152
    s_add_u32 s45, s45, s46
    s_mov_b64 vcc, 0
    s_call_b64 s[50:51], L_wi
    ds_read_b32 v47, v55 offset:2816
    s_mov_b32 s40, 0xffff0000
    s_mul_i32 s44, s59, 9216
    s_add_u32 s44, s44, 0x70000
    s_add_u32 s45, s44, 4096
    s_add_u32 s46, s44, 8192
    s_mul_i32 s41, s98, 9
    s_add_u32 s41, s41, s62
    s_lshl_b32 s41, s41, 7
    s_lshl_b32 s47, s3, 3
    s_add_u32 s41, s41, s47
    s_add_u32 s41, s41, 0xc2000
    s_mov_b32 s42, 0x00ff00ff
    s_mov_b32 s43, 0x00ff00ff
    s_cmp_eq_u32 s99, 0
    s_cselect_b64 s[48:49], 3, 0
    v_mov_b32 v20, 0
    s_waitcnt vmcnt(0) lgkmcnt(0)
    v_sub_f32 v47, v53, v47
    s_barrier
    ds_read_b32 v44, v20 offset:2824
    buffer_load_dwordx4 v[140:143], v50, s[28:31], s44 offen offset:0 sc1
    buffer_load_dwordx4 v[144:147], v50, s[28:31], s44 offen offset:1024 sc1
    buffer_load_dwordx4 v[148:151], v50, s[28:31], s44 offen offset:2048 sc1
    buffer_load_dwordx4 v[152:155], v50, s[28:31], s44 offen offset:3072 sc1
    buffer_load_dwordx4 v[156:159], v50, s[28:31], s45 offen offset:0 sc1
    buffer_load_dwordx4 v[160:163], v50, s[28:31], s45 offen offset:1024 sc1
    buffer_load_dwordx4 v[164:167], v50, s[28:31], s45 offen offset:2048 sc1
    buffer_load_dwordx4 v[168:171], v50, s[28:31], s45 offen offset:3072 sc1
    s_call_b64 s[50:51], L_wr
    v_readfirstlane_b32 s96, v44
    s_nop 3
    s_cmp_lg_u32 s96, 0
    s_cselect_b64 s[52:53], 0, s[48:49]
    s_cselect_b64 s[48:49], s[48:49], 0
    s_mov_b32 s60, 0
    s_branch L_r1_poll_c
L_r1_poll:
    buffer_load_dwordx4 v[140:143], v50, s[28:31], s44 offen offset:0 sc1
    buffer_load_dwordx4 v[144:147], v50, s[28:31], s44 offen offset:1024 sc1
    buffer_load_dwordx4 v[148:151], v50, s[28:31], s44 offen offset:2048 sc1
    buffer_load_dwordx4 v[152:155], v50, s[28:31], s44 offen offset:3072 sc1
    buffer_load_dwordx4 v[156:159], v50, s[28:31], s45 offen offset:0 sc1
    buffer_load_dwordx4 v[160:163], v50, s[28:31], s45 offen offset:1024 sc1
    buffer_load_dwordx4 v[164:167], v50, s[28:31], s45 offen offset:2048 sc1
    buffer_load_dwordx4 v[168:171], v50, s[28:31], s45 offen offset:3072 sc1
L_r1_poll_c:
    s_waitcnt vmcnt(6)
    v_pk_add_f32 v[140:141], v[140:141], v[144:145]
    v_pk_add_f32 v[142:143], v[142:143], v[146:147]
    s_waitcnt vmcnt(5)
    v_pk_add_f32 v[140:141], v[140:141], v[148:149]
    v_pk_add_f32 v[142:143], v[142:143], v[150:151]
    s_waitcnt vmcnt(4)
    v_pk_add_f32 v[140:141], v[140:141], v[152:153]
    v_pk_add_f32 v[142:143], v[142:143], v[154:155]
    s_waitcnt vmcnt(3)
    v_pk_add_f32 v[140:141], v[140:141], v[156:157]
    v_pk_add_f32 v[142:143], v[142:143], v[158:159]
    s_waitcnt vmcnt(2)
    v_pk_add_f32 v[140:141], v[140:141], v[160:161]
    v_pk_add_f32 v[142:143], v[142:143], v[162:163]
    s_waitcnt vmcnt(1)
    v_pk_add_f32 v[140:141], v[140:141], v[164:165]
    v_pk_add_f32 v[142:143], v[142:143], v[166:167]
    s_waitcnt vmcnt(0)
    v_pk_add_f32 v[140:141], v[140:141], v[168:169]
    v_pk_add_f32 v[142:143], v[142:143], v[170:171]
    s_add_u32 s60, s60, 1
    s_cmp_gt_u32 s60, 200000
    v_permlane32_swap_b32 v140, v142
    v_permlane32_swap_b32 v141, v143
    v_add_f32 v140, v140, v142
    v_add_f32 v141, v141, v143
    s_nop 1
    v_permlane16_swap_b32 v140, v141
    v_add_f32 v140, v140, v141
    s_nop 1
    v_add_f32_dpp v140, v140, v140 row_ror:8 row_mask:0xf bank_mask:0xf
    v_cmp_u_f32 vcc, v140, v140
    s_cbranch_scc1 L_r1_poll_x
    s_cbranch_vccnz L_r1_poll
L_r1_poll_x:
    v_add_f32 v24, v47, v140
    v_cvt_pk_bf16_f32 v13, v24, v24
    s_mov_b64 exec, s[42:43]
    ds_write_b16 v54, v13 offset:7680
    s_mov_b64 exec, -1
    v_mov_b32 v46, v140
    v_mul_f32 v24, v24, v24
    v_mov_b32 v25, v24
    s_waitcnt lgkmcnt(0)
    s_barrier
    ds_read_b128 v[140:143], v56 offset:0
    ds_read_b128 v[144:147], v56 offset:64
    ds_read_b128 v[148:151], v57 offset:0
    ds_read_b128 v[152:155], v57 offset:64
    ds_read_b128 v[156:159], v58 offset:0
    ds_read_b128 v[160:163], v58 offset:64
    s_waitcnt lgkmcnt(5)
    v_mfma_f32_16x16x32_bf16 v[12:15], v[64:67], v[140:143], 0
    ds_read_b128 v[164:167], v59 offset:0
    v_mfma_f32_16x16x32_bf16 v[16:19], v[128:131], v[140:143], 0
    ds_read_b128 v[168:171], v59 offset:64
    v_permlane32_swap_b32 v24, v25
    v_add_f32 v24, v24, v25
    v_mov_b32 v25, v24
    s_waitcnt lgkmcnt(6)
    v_mfma_f32_16x16x32_bf16 v[12:15], v[68:71], v[144:147], v[12:15]
    ds_read_b128 v[172:175], v60 offset:0
    v_mfma_f32_16x16x32_bf16 v[16:19], v[132:135], v[144:147], v[16:19]
    ds_read_b128 v[176:179], v60 offset:64
    v_permlane16_swap_b32 v24, v25
    v_add_f32 v24, v24, v25
    s_waitcnt lgkmcnt(7)
    v_mfma_f32_16x16x32_bf16 v[12:15], v[72:75], v[148:151], v[12:15]
    ds_read_b128 v[180:183], v61 offset:0
    v_add_f32_dpp v24, v24, v24 quad_perm:[2,3,0,1] row_mask:0xf bank_mask:0xf
    s_waitcnt lgkmcnt(7)
    v_mfma_f32_16x16x32_bf16 v[12:15], v[76:79], v[152:155], v[12:15]
    ds_read_b128 v[184:187], v61 offset:64
    v_add_f32_dpp v24, v24, v24 row_ror:4 row_mask:0xf bank_mask:0xf
    s_waitcnt lgkmcnt(7)
    v_mfma_f32_16x16x32_bf16 v[12:15], v[80:83], v[156:159], v[12:15]
    ds_read_b128 v[188:191], v62 offset:0
    s_mov_b64 exec, s[48:49]
    buffer_store_dword v24, v55, s[28:31], s41 offen
    s_mov_b64 exec, s[52:53]
    buffer_store_dword v24, v55, s[28:31], s41 offen sc1
    s_mov_b64 exec, -1
    s_cmp_lg_u32 s96, 0
    s_waitcnt lgkmcnt(7)
    v_mfma_f32_16x16x32_bf16 v[12:15], v[84:87], v[160:163], v[12:15]
    ds_read_b128 v[192:195], v62 offset:64
    s_waitcnt lgkmcnt(7)
    v_mfma_f32_16x16x32_bf16 v[12:15], v[88:91], v[164:167], v[12:15]
    ds_read_b128 v[196:199], v63 offset:0
    s_waitcnt lgkmcnt(7)
    v_mfma_f32_16x16x32_bf16 v[12:15], v[92:95], v[168:171], v[12:15]
    ds_read_b128 v[200:203], v63 offset:64
    s_waitcnt lgkmcnt(7)
    v_mfma_f32_16x16x32_bf16 v[12:15], v[96:99], v[172:175], v[12:15]
    s_waitcnt lgkmcnt(6)
    v_mfma_f32_16x16x32_bf16 v[12:15], v[100:103], v[176:179], v[12:15]
    s_waitcnt lgkmcnt(5)
    v_mfma_f32_16x16x32_bf16 v[12:15], v[104:107], v[180:183], v[12:15]
    s_waitcnt lgkmcnt(4)
    v_mfma_f32_16x16x32_bf16 v[12:15], v[108:111], v[184:187], v[12:15]
    s_waitcnt lgkmcnt(3)
    v_mfma_f32_16x16x32_bf16 v[12:15], v[112:115], v[188:191], v[12:15]
    s_waitcnt lgkmcnt(2)
    v_mfma_f32_16x16x32_bf16 v[12:15], v[116:119], v[192:195], v[12:15]
    s_waitcnt lgkmcnt(1)
    v_mfma_f32_16x16x32_bf16 v[12:15], v[120:123], v[196:199], v[12:15]
    s_waitcnt lgkmcnt(0)
    v_mfma_f32_16x16x32_bf16 v[12:15], v[124:127], v[200:203], v[12:15]
    s_cbranch_scc0 L_mm_r
    s_mov_b64 exec, s[56:57]
    buffer_store_dwordx4 v[16:19], v49, s[28:31], s55 offen
    s_mov_b64 exec, -1
    s_nop 3
    buffer_store_dwordx4 v[12:15], v52, s[28:31], s54 offen
    s_branch L_mm_l
L_mm_r:
    s_mov_b64 exec, s[56:57]
    buffer_store_dwordx4 v[16:19], v49, s[28:31], s55 offen sc1
    s_mov_b64 exec, -1
    s_nop 3
    buffer_store_dwordx4 v[12:15], v52, s[28:31], s54 offen sc1
L_mm_l:
    s_cmp_eq_u32 s3, s63
    s_cbranch_scc1 L_a_red
    s_endpgm
L_a_red:
    s_mov_b32 s36, s22
    s_mov_b32 s37, s23
    s_mov_b32 s38, 0x900
    s_mov_b32 s39, 0x20000
    s_mov_b32 s47, 0xc1000
    s_mov_b32 s60, 0
L_mu_poll:
    buffer_load_dword v12, v50, s[28:31], s47 offen sc1
    buffer_load_dword v13, v50, s[28:31], s47 offen offset:1024 sc1
    s_waitcnt vmcnt(0)
    v_max_u32 v14, v12, v13
    v_cmp_eq_u32 vcc, -1, v14
    s_add_u32 s60, s60, 1
    s_cmp_gt_u32 s60, 200000
    s_cbranch_scc1 L_mu_poll_x
    s_cbranch_vccnz L_mu_poll
L_mu_poll_x:
    v_add_f32 v12, v12, v13
    v_mov_b32 v13, v12
    s_nop 1
    v_permlane16_swap_b32 v12, v13
    s_nop 0
    v_add_f32 v12, v12, v13
    v_mov_b32 v13, v12
    s_nop 1
    v_permlane32_swap_b32 v12, v13
    s_nop 0
    v_add_f32 v12, v12, v13
    s_nop 1
    v_add_f32_dpp v12, v12, v12 row_ror:8 row_mask:0xf bank_mask:0xf
    s_nop 1
    v_add_f32_dpp v12, v12, v12 row_ror:4 row_mask:0xf bank_mask:0xf
    s_nop 1
    v_add_f32_dpp v12, v12, v12 row_ror:2 row_mask:0xf bank_mask:0xf
    v_sub_f32 v46, v46, v12
    v_cvt_pk_bf16_f32 v46, v46, v46
    v_and_b32 v46, s40, v46
    v_add_f32 v53, v53, v46
    v_cvt_pk_bf16_f32 v53, v53, v53
    v_and_b32 v53, s40, v53
    s_add_u32 s44, s44, 0x60000
    s_add_u32 s45, s45, 0x60000
    s_add_u32 s46, s46, 0x60000
    s_mov_b32 s60, 0
L_r2_poll:
    buffer_load_dwordx4 v[140:143], v50, s[28:31], s44 offen offset:0 sc1
    buffer_load_dwordx4 v[144:147], v50, s[28:31], s44 offen offset:1024 sc1
    buffer_load_dwordx4 v[148:151], v50, s[28:31], s44 offen offset:2048 sc1
    buffer_load_dwordx4 v[152:155], v50, s[28:31], s44 offen offset:3072 sc1
    buffer_load_dwordx4 v[156:159], v50, s[28:31], s45 offen offset:0 sc1
    buffer_load_dwordx4 v[160:163], v50, s[28:31], s45 offen offset:1024 sc1
    buffer_load_dwordx4 v[164:167], v50, s[28:31], s45 offen offset:2048 sc1
    buffer_load_dwordx4 v[168:171], v50, s[28:31], s45 offen offset:3072 sc1
    buffer_load_dwordx4 v[172:175], v50, s[28:31], s46 offen offset:0 sc1
    s_waitcnt vmcnt(7)
    v_pk_add_f32 v[140:141], v[140:141], v[144:145]
    v_pk_add_f32 v[142:143], v[142:143], v[146:147]
    s_waitcnt vmcnt(6)
    v_pk_add_f32 v[140:141], v[140:141], v[148:149]
    v_pk_add_f32 v[142:143], v[142:143], v[150:151]
    s_waitcnt vmcnt(5)
    v_pk_add_f32 v[140:141], v[140:141], v[152:153]
    v_pk_add_f32 v[142:143], v[142:143], v[154:155]
    s_waitcnt vmcnt(4)
    v_pk_add_f32 v[140:141], v[140:141], v[156:157]
    v_pk_add_f32 v[142:143], v[142:143], v[158:159]
    s_waitcnt vmcnt(3)
    v_pk_add_f32 v[140:141], v[140:141], v[160:161]
    v_pk_add_f32 v[142:143], v[142:143], v[162:163]
    s_waitcnt vmcnt(2)
    v_pk_add_f32 v[140:141], v[140:141], v[164:165]
    v_pk_add_f32 v[142:143], v[142:143], v[166:167]
    s_waitcnt vmcnt(1)
    v_pk_add_f32 v[140:141], v[140:141], v[168:169]
    v_pk_add_f32 v[142:143], v[142:143], v[170:171]
    s_waitcnt vmcnt(0)
    v_pk_add_f32 v[140:141], v[140:141], v[172:173]
    v_pk_add_f32 v[142:143], v[142:143], v[174:175]
    s_add_u32 s60, s60, 1
    s_cmp_gt_u32 s60, 200000
    v_permlane32_swap_b32 v140, v142
    v_permlane32_swap_b32 v141, v143
    v_add_f32 v140, v140, v142
    v_add_f32 v141, v141, v143
    s_nop 1
    v_permlane16_swap_b32 v140, v141
    v_add_f32 v140, v140, v141
    s_nop 1
    v_add_f32_dpp v140, v140, v140 row_ror:8 row_mask:0xf bank_mask:0xf
    v_cmp_u_f32 vcc, v140, v140
    s_cbranch_scc1 L_r2_poll_x
    s_cbranch_vccnz L_r2_poll
L_r2_poll_x:
    v_cvt_pk_bf16_f32 v140, v140, v140
    v_and_b32 v140, s40, v140
    v_add_f32 v53, v53, v140
    v_cvt_pk_bf16_f32 v53, v53, v53
    s_mov_b64 exec, s[42:43]
    buffer_store_short v53, v51, s[36:39], 0 offen
    s_cmp_lg_u32 s59, 0
    s_cbranch_scc1 L_red_end
    s_mov_b64 exec, 1
    v_mov_b32 v16, s61
    v_mov_b32 v17, 0
    buffer_store_dword v16, v17, s[28:31], 0 offen offset:0 sc1
L_red_end:
    s_endpgm
L_end:
    s_endpgm
.section .rodata,"a"
.p2align 6
.amdhsa_kernel sequential_preLN__gqa_block_cached__geglu_ffn__decode_kernel
  .amdhsa_next_free_vgpr 256
  .amdhsa_next_free_sgpr 102
  .amdhsa_accum_offset 256
  .amdhsa_group_segment_fixed_size 0
  .amdhsa_kernarg_size 96
  .amdhsa_user_sgpr_count 2
  .amdhsa_user_sgpr_kernarg_segment_ptr 1
  .amdhsa_system_sgpr_workgroup_id_x 1
.end_amdhsa_kernel
```
